```python
import torch

def _softmax(x, axis=-1):
    return torch.softmax(x, dim=axis)

def _gelu(x):
    return torch.nn.functional.gelu(x, approximate='tanh')

def _silu(x):
    return torch.nn.functional.silu(x)

def _sigmoid(x):
    return torch.sigmoid(x)

def _layernorm(x, axis=-1, eps=1e-05):
    m = x.mean(dim=axis, keepdim=True)
    v = x.var(dim=axis, keepdim=True, unbiased=False)
    return (x - m) / torch.sqrt(v + eps)

def _scatter_add(tgt, idx, src, axis=0):
    return tgt.clone().index_add_(axis, idx, src)

def _segment_sum(src, seg, n):
    out = torch.zeros((n,) + src.shape[1:], dtype=src.dtype)
    return out.index_add_(0, seg, src)

def _pad(x, pw):
    flat = tuple((v for pair in reversed(pw) for v in pair))
    return torch.nn.functional.pad(x, flat)
kernel_name = 'parallel_sum__memory_aug_recurrent_mem_tr__dense_activation_gelu__prompt'

def setup_inputs():

    _w = lambda a: (lambda t: t.to(torch.bfloat16) if t.is_floating_point() else t)(torch.as_tensor(a))

    def _A_setup():
        B, S, Dm = (1, 2048, 1024)
        H, Dh = (32, 128)
        M, seg = (8, 32)
        seg = min(seg, S)
        S = S // seg * seg
        return {'x': _w((lambda *s: torch.randn(*s, dtype=torch.bfloat16) * 0.05)(B, S, Dm)), 'mem0': _w((lambda *s: torch.randn(*s, dtype=torch.bfloat16) * 0.2)(B, M, Dm)), 'Wq': _w((lambda *s: torch.randn(*s, dtype=torch.bfloat16) * 1.6)(Dm, H, Dh) * Dm ** (-0.5)), 'Wk': _w((lambda *s: torch.randn(*s, dtype=torch.bfloat16) * 1.6)(Dm, H, Dh) * Dm ** (-0.5)), 'Wv': _w((lambda *s: torch.randn(*s, dtype=torch.bfloat16) * 0.2)(Dm, H, Dh) * Dm ** (-0.5)), 'Wo': _w((lambda *s: torch.randn(*s, dtype=torch.bfloat16) * 0.2)(H, Dh, Dm) * (H * Dh) ** (-0.5)), 'seg_len': seg}
    _A_in = _A_setup()

    def _B_setup():
        B, S, D, F = (1, 2048, 1024, 3584)
        return {'x': _w((lambda *s: torch.randn(*s, dtype=torch.bfloat16) * 0.05)(B, S, D)), 'w1': _w((lambda *s: torch.randn(*s, dtype=torch.bfloat16) * 0.4)(D, F) * D ** (-0.5)), 'b1': _w((lambda *s: torch.randn(*s, dtype=torch.bfloat16) * 12.8)(F) * 0.01), 'w2': _w((lambda *s: torch.randn(*s, dtype=torch.bfloat16) * 0.1)(F, D) * F ** (-0.5)), 'b2': _w((lambda *s: torch.randn(*s, dtype=torch.bfloat16) * 1.6)(D) * 0.01)}
    _B_in = _B_setup()
    return {'A_x': _A_in['x'], 'A_mem0': _A_in['mem0'], 'A_Wq': _A_in['Wq'], 'A_Wk': _A_in['Wk'], 'A_Wv': _A_in['Wv'], 'A_Wo': _A_in['Wo'], 'A_seg_len': _A_in['seg_len'], 'B_x': _B_in['x'], 'B_w1': _B_in['w1'], 'B_b1': _B_in['b1'], 'B_w2': _B_in['w2'], 'B_b2': _B_in['b2']}

def reference(A_x, A_mem0, A_Wq, A_Wk, A_Wv, A_Wo, A_seg_len, B_x, B_w1, B_b1, B_w2, B_b2):

    def _A_ref(x, mem0, Wq, Wk, Wv, Wo, seg_len):
        B, S, Dm = x.shape
        H, Dh = (Wq.shape[1], Wq.shape[2])
        M = mem0.shape[1]
        scale = Dh ** (-0.5)
        n_seg = S // seg_len
        L = M + seg_len
        idx = torch.arange(L)
        mask = (idx[:, None] < M) | (idx[:, None] >= idx[None, :])
        mem = mem0
        outs = []
        for s in range(n_seg):
            xs = x[:, s * seg_len:(s + 1) * seg_len, :].clone()
            h = torch.concatenate([mem, xs], axis=1)
            q = torch.einsum('btd,dhe->bhte', h, Wq)
            k = torch.einsum('btd,dhe->bhte', h, Wk)
            v = torch.einsum('btd,dhe->bhte', h, Wv)
            scores = torch.einsum('bhqe,bhke->bhqk', q, k) * scale
            scores = torch.where(mask[None, None], scores, -1000000000.0)
            p = _softmax(scores, axis=-1)
            o = torch.einsum('bhqk,bhke->bhqe', p, v)
            o = torch.einsum('bhte,hed->btd', o, Wo)
            mem = o[:, :M, :].clone()
            outs.append(o[:, M:, :])
        return torch.concatenate(outs, axis=1)

    def _B_ref(x, w1, b1, w2, b2):
        h = torch.einsum('bsd,df->bsf', x, w1) + b1
        h = _gelu(h)
        return torch.einsum('bsf,fd->bsd', h, w2) + b2
    x = A_x
    xn = _layernorm(x, axis=-1)
    return x + _A_ref(xn, A_mem0, A_Wq, A_Wk, A_Wv, A_Wo, A_seg_len) + _B_ref(xn, B_w1, B_b1, B_w2, B_b2)
```

```asm
; @launch kernel=k1_ln_kernel grid=(512,1,1) block=(256,1,1) lds=0
; @launch kernel=k2_gemm_kernel grid=(1984,1,1) block=(256,1,1) lds=40960
; @launch kernel=k3_rec_kernel grid=(256,1,1) block=(256,1,1) lds=163840
; @launch kernel=k4_attn_kernel grid=(512,1,1) block=(256,1,1) lds=52224
; @launch kernel=k5_gemm_kernel grid=(256,1,1) block=(256,1,1) lds=40960
; @launch kernel=k6_comb_kernel grid=(1024,1,1) block=(256,1,1) lds=0
.amdgcn_target "amdgcn-amd-amdhsa--gfx950"
.text
.globl k1_ln_kernel
.p2align 8
.type k1_ln_kernel,@function
k1_ln_kernel:
    s_cmp_ge_u32 s2, 512
    s_cbranch_scc1 K1_END
    s_load_dwordx2 s[4:5], s[0:1], 0
    s_load_dwordx2 s[6:7], s[0:1], 112
    s_waitcnt lgkmcnt(0)

    s_mov_b32 s8, s4
    s_and_b32 s9, s5, 0xffff
    s_mov_b32 s10, 4194304
    s_mov_b32 s11, 0x00020000

    s_mov_b32 s12, s6
    s_and_b32 s13, s7, 0xffff
    s_mov_b32 s14, 268435456
    s_mov_b32 s15, 0x00020000

    v_lshrrev_b32 v1, 6, v0
    v_and_b32 v2, 63, v0
    s_lshl_b32 s3, s2, 2
    v_add_u32 v1, s3, v1
    v_lshlrev_b32 v3, 11, v1
    v_lshl_add_u32 v3, v2, 5, v3
    buffer_load_dwordx4 v[10:13], v3, s[8:11], 0 offen
    buffer_load_dwordx4 v[14:17], v3, s[8:11], 0 offen offset:16

    s_lshl_b32 s3, s2, 8
    v_add_u32 v4, s3, v0
    v_lshlrev_b32 v4, 4, v4
    v_mov_b32 v40, -1
    v_mov_b32 v41, -1
    v_mov_b32 v42, -1
    v_mov_b32 v43, -1
    v_mov_b32 v44, 0
    v_mov_b32 v45, 0
    v_mov_b32 v46, 0
    v_mov_b32 v47, 0
    s_mov_b32 s20, 88080384

    buffer_store_dwordx4 v[40:43], v4, s[12:15], s20 offen
    s_add_u32 s20, s20, 2097152

    buffer_store_dwordx4 v[40:43], v4, s[12:15], s20 offen
    s_add_u32 s20, s20, 2097152

    buffer_store_dwordx4 v[40:43], v4, s[12:15], s20 offen
    s_add_u32 s20, s20, 2097152

    buffer_store_dwordx4 v[40:43], v4, s[12:15], s20 offen
    s_add_u32 s20, s20, 2097152

    buffer_store_dwordx4 v[40:43], v4, s[12:15], s20 offen
    s_add_u32 s20, s20, 2097152

    buffer_store_dwordx4 v[40:43], v4, s[12:15], s20 offen
    s_add_u32 s20, s20, 2097152

    buffer_store_dwordx4 v[40:43], v4, s[12:15], s20 offen
    s_add_u32 s20, s20, 2097152

    s_mov_b32 s20, 102760448
    buffer_store_dwordx4 v[44:47], v4, s[12:15], s20 offen
    s_waitcnt vmcnt(8)

    v_lshlrev_b32 v20, 16, v10
    v_and_b32 v21, 0xffff0000, v10

    v_lshlrev_b32 v22, 16, v11
    v_and_b32 v23, 0xffff0000, v11

    v_lshlrev_b32 v24, 16, v12
    v_and_b32 v25, 0xffff0000, v12

    v_lshlrev_b32 v26, 16, v13
    v_and_b32 v27, 0xffff0000, v13

    v_lshlrev_b32 v28, 16, v14
    v_and_b32 v29, 0xffff0000, v14

    v_lshlrev_b32 v30, 16, v15
    v_and_b32 v31, 0xffff0000, v15

    v_lshlrev_b32 v32, 16, v16
    v_and_b32 v33, 0xffff0000, v16

    v_lshlrev_b32 v34, 16, v17
    v_and_b32 v35, 0xffff0000, v17

    v_add_f32 v5, v20, v21
    v_add_f32 v5, v5, v22
    v_add_f32 v5, v5, v23
    v_add_f32 v5, v5, v24
    v_add_f32 v5, v5, v25
    v_add_f32 v5, v5, v26
    v_add_f32 v5, v5, v27
    v_add_f32 v5, v5, v28
    v_add_f32 v5, v5, v29
    v_add_f32 v5, v5, v30
    v_add_f32 v5, v5, v31
    v_add_f32 v5, v5, v32
    v_add_f32 v5, v5, v33
    v_add_f32 v5, v5, v34
    v_add_f32 v5, v5, v35
    s_nop 1
    v_add_f32_dpp v6, v5, v5 quad_perm:[1,0,3,2] row_mask:0xf bank_mask:0xf
    s_nop 1
    v_add_f32_dpp v5, v6, v6 quad_perm:[2,3,0,1] row_mask:0xf bank_mask:0xf
    s_nop 1
    v_add_f32_dpp v6, v5, v5 row_half_mirror row_mask:0xf bank_mask:0xf
    s_nop 1
    v_add_f32_dpp v5, v6, v6 row_mirror row_mask:0xf bank_mask:0xf
    s_nop 1
    v_readlane_b32 s24, v5, 0
    v_readlane_b32 s25, v5, 16
    v_readlane_b32 s26, v5, 32
    v_readlane_b32 s27, v5, 48
    s_nop 1
    v_mov_b32 v6, s24
    v_add_f32 v6, s25, v6
    v_add_f32 v6, s26, v6
    v_add_f32 v6, s27, v6
    s_nop 0
    v_readfirstlane_b32 s24, v6
    s_nop 1

    s_mov_b32 s28, 0x3a800000
    v_mov_b32 v7, s28
    v_mul_f32 v7, s24, v7

    v_sub_f32 v50, v20, v7
    v_sub_f32 v51, v21, v7
    v_sub_f32 v52, v22, v7
    v_sub_f32 v53, v23, v7
    v_sub_f32 v54, v24, v7
    v_sub_f32 v55, v25, v7
    v_sub_f32 v56, v26, v7
    v_sub_f32 v57, v27, v7
    v_sub_f32 v58, v28, v7
    v_sub_f32 v59, v29, v7
    v_sub_f32 v60, v30, v7
    v_sub_f32 v61, v31, v7
    v_sub_f32 v62, v32, v7
    v_sub_f32 v63, v33, v7
    v_sub_f32 v64, v34, v7
    v_sub_f32 v65, v35, v7
    v_mul_f32 v5, v50, v50
    v_fmac_f32 v5, v51, v51
    v_fmac_f32 v5, v52, v52
    v_fmac_f32 v5, v53, v53
    v_fmac_f32 v5, v54, v54
    v_fmac_f32 v5, v55, v55
    v_fmac_f32 v5, v56, v56
    v_fmac_f32 v5, v57, v57
    v_fmac_f32 v5, v58, v58
    v_fmac_f32 v5, v59, v59
    v_fmac_f32 v5, v60, v60
    v_fmac_f32 v5, v61, v61
    v_fmac_f32 v5, v62, v62
    v_fmac_f32 v5, v63, v63
    v_fmac_f32 v5, v64, v64
    v_fmac_f32 v5, v65, v65
    s_nop 1
    v_add_f32_dpp v6, v5, v5 quad_perm:[1,0,3,2] row_mask:0xf bank_mask:0xf
    s_nop 1
    v_add_f32_dpp v5, v6, v6 quad_perm:[2,3,0,1] row_mask:0xf bank_mask:0xf
    s_nop 1
    v_add_f32_dpp v6, v5, v5 row_half_mirror row_mask:0xf bank_mask:0xf
    s_nop 1
    v_add_f32_dpp v5, v6, v6 row_mirror row_mask:0xf bank_mask:0xf
    s_nop 1
    v_readlane_b32 s24, v5, 0
    v_readlane_b32 s25, v5, 16
    v_readlane_b32 s26, v5, 32
    v_readlane_b32 s27, v5, 48
    s_nop 1
    v_mov_b32 v6, s24
    v_add_f32 v6, s25, v6
    v_add_f32 v6, s26, v6
    v_add_f32 v6, s27, v6
    s_nop 0
    v_readfirstlane_b32 s24, v6
    s_nop 1

    v_mov_b32 v8, s28
    v_mul_f32 v8, s24, v8
    v_cvt_pk_bf16_f32 v9, v7, v8
    v_lshlrev_b32 v7, 16, v9
    v_and_b32 v8, 0xffff0000, v9
    v_add_f32 v8, 0x3727c5ac, v8
    v_cvt_pk_bf16_f32 v9, v8, v8
    v_and_b32 v8, 0xffff0000, v9
    v_sqrt_f32 v8, v8
    s_nop 0
    v_cvt_pk_bf16_f32 v9, v8, v8
    v_and_b32 v8, 0xffff0000, v9
    v_rcp_f32 v9, v8
    s_nop 0

    v_sub_f32 v50, v20, v7
    v_sub_f32 v51, v21, v7
    v_sub_f32 v52, v22, v7
    v_sub_f32 v53, v23, v7
    v_sub_f32 v54, v24, v7
    v_sub_f32 v55, v25, v7
    v_sub_f32 v56, v26, v7
    v_sub_f32 v57, v27, v7
    v_sub_f32 v58, v28, v7
    v_sub_f32 v59, v29, v7
    v_sub_f32 v60, v30, v7
    v_sub_f32 v61, v31, v7
    v_sub_f32 v62, v32, v7
    v_sub_f32 v63, v33, v7
    v_sub_f32 v64, v34, v7
    v_sub_f32 v65, v35, v7
    v_cvt_pk_bf16_f32 v10, v50, v51

    v_cvt_pk_bf16_f32 v11, v52, v53

    v_cvt_pk_bf16_f32 v12, v54, v55

    v_cvt_pk_bf16_f32 v13, v56, v57

    v_cvt_pk_bf16_f32 v14, v58, v59

    v_cvt_pk_bf16_f32 v15, v60, v61

    v_cvt_pk_bf16_f32 v16, v62, v63

    v_cvt_pk_bf16_f32 v17, v64, v65

    v_lshlrev_b32 v50, 16, v10
    v_and_b32 v51, 0xffff0000, v10

    v_lshlrev_b32 v52, 16, v11
    v_and_b32 v53, 0xffff0000, v11

    v_lshlrev_b32 v54, 16, v12
    v_and_b32 v55, 0xffff0000, v12

    v_lshlrev_b32 v56, 16, v13
    v_and_b32 v57, 0xffff0000, v13

    v_lshlrev_b32 v58, 16, v14
    v_and_b32 v59, 0xffff0000, v14

    v_lshlrev_b32 v60, 16, v15
    v_and_b32 v61, 0xffff0000, v15

    v_lshlrev_b32 v62, 16, v16
    v_and_b32 v63, 0xffff0000, v16

    v_lshlrev_b32 v64, 16, v17
    v_and_b32 v65, 0xffff0000, v17

    v_mul_f32 v66, v50, v9
    v_fma_f32 v6, -v66, v8, v50
    v_fma_f32 v66, v6, v9, v66

    v_mul_f32 v67, v51, v9
    v_fma_f32 v6, -v67, v8, v51
    v_fma_f32 v67, v6, v9, v67

    v_mul_f32 v68, v52, v9
    v_fma_f32 v6, -v68, v8, v52
    v_fma_f32 v68, v6, v9, v68

    v_mul_f32 v69, v53, v9
    v_fma_f32 v6, -v69, v8, v53
    v_fma_f32 v69, v6, v9, v69

    v_mul_f32 v70, v54, v9
    v_fma_f32 v6, -v70, v8, v54
    v_fma_f32 v70, v6, v9, v70

    v_mul_f32 v71, v55, v9
    v_fma_f32 v6, -v71, v8, v55
    v_fma_f32 v71, v6, v9, v71

    v_mul_f32 v72, v56, v9
    v_fma_f32 v6, -v72, v8, v56
    v_fma_f32 v72, v6, v9, v72

    v_mul_f32 v73, v57, v9
    v_fma_f32 v6, -v73, v8, v57
    v_fma_f32 v73, v6, v9, v73

    v_mul_f32 v74, v58, v9
    v_fma_f32 v6, -v74, v8, v58
    v_fma_f32 v74, v6, v9, v74

    v_mul_f32 v75, v59, v9
    v_fma_f32 v6, -v75, v8, v59
    v_fma_f32 v75, v6, v9, v75

    v_mul_f32 v76, v60, v9
    v_fma_f32 v6, -v76, v8, v60
    v_fma_f32 v76, v6, v9, v76

    v_mul_f32 v77, v61, v9
    v_fma_f32 v6, -v77, v8, v61
    v_fma_f32 v77, v6, v9, v77

    v_mul_f32 v78, v62, v9
    v_fma_f32 v6, -v78, v8, v62
    v_fma_f32 v78, v6, v9, v78

    v_mul_f32 v79, v63, v9
    v_fma_f32 v6, -v79, v8, v63
    v_fma_f32 v79, v6, v9, v79

    v_mul_f32 v80, v64, v9
    v_fma_f32 v6, -v80, v8, v64
    v_fma_f32 v80, v6, v9, v80

    v_mul_f32 v81, v65, v9
    v_fma_f32 v6, -v81, v8, v65
    v_fma_f32 v81, v6, v9, v81

    v_cvt_pk_bf16_f32 v10, v66, v67
    v_cvt_pk_bf16_f32 v11, v68, v69
    v_cvt_pk_bf16_f32 v12, v70, v71
    v_cvt_pk_bf16_f32 v13, v72, v73
    v_cvt_pk_bf16_f32 v14, v74, v75
    v_cvt_pk_bf16_f32 v15, v76, v77
    v_cvt_pk_bf16_f32 v16, v78, v79
    v_cvt_pk_bf16_f32 v17, v80, v81
    s_mov_b32 s20, 0
    buffer_store_dwordx4 v[10:13], v3, s[12:15], s20 offen
    buffer_store_dwordx4 v[14:17], v3, s[12:15], s20 offen offset:16

K1_END:
    s_endpgm
.globl k2_gemm_kernel
.p2align 8
.type k2_gemm_kernel,@function
k2_gemm_kernel:
    s_cmp_ge_u32 s2, 1984
    s_cbranch_scc1 K2_END
    s_load_dwordx2 s[4:5], s[0:1], 16
    s_load_dwordx2 s[6:7], s[0:1], 24
    s_load_dwordx2 s[8:9], s[0:1], 32
    s_load_dwordx2 s[10:11], s[0:1], 64
    s_load_dwordx2 s[12:13], s[0:1], 112
    s_load_dwordx2 s[14:15], s[0:1], 72
    s_and_b32 s16, s2, 15
    s_lshr_b32 s17, s2, 4
    s_waitcnt lgkmcnt(0)

    s_lshr_b32 s18, s17, 5
    s_mov_b32 s20, s4
    s_mov_b32 s21, s5
    s_mov_b32 s22, 4194304
    s_cmp_eq_u32 s18, 1
    s_cselect_b32 s20, s6, s20
    s_cselect_b32 s21, s7, s21
    s_cselect_b32 s22, 20971520, s22
    s_cmp_eq_u32 s18, 2
    s_cselect_b32 s20, s8, s20
    s_cselect_b32 s21, s9, s21
    s_cselect_b32 s22, 37748736, s22
    s_mov_b32 s23, 8388608
    s_mov_b32 s43, 8192
    s_mov_b32 s24, 8192
    s_cmp_eq_u32 s18, 3
    s_cselect_b32 s20, s10, s20
    s_cselect_b32 s21, s11, s21
    s_cselect_b32 s22, 54525952, s22
    s_cselect_b32 s23, 7340032, s23
    s_cselect_b32 s43, 7168, s43
    s_cselect_b32 s24, 7168, s24
    s_and_b32 s19, s17, 31
    s_lshl_b32 s41, s19, 8
    s_lshl_b32 s40, s16, 7
    s_mov_b32 s42, 2048

    s_mov_b32 s28, s12
    s_and_b32 s29, s13, 0xffff
    s_mov_b32 s30, 268435456
    s_mov_b32 s31, 0x00020000

    s_mov_b32 s32, s20
    s_and_b32 s33, s21, 0xffff
    s_mov_b32 s34, s23
    s_mov_b32 s35, 0x00020000

    s_mov_b32 s36, s14
    s_and_b32 s37, s15, 0xffff
    s_mov_b32 s38, 7168
    s_mov_b32 s39, 0x00020000

    v_lshrrev_b32 v9, 2, v0
    v_and_b32 v10, 3, v0
    v_add_u32 v11, s40, v9
    v_mul_lo_u32 v1, v11, s42
    v_lshl_add_u32 v1, v10, 4, v1
    s_lshl_b32 s44, s42, 6
    v_add_u32 v2, s44, v1
    v_mul_u32_u24 v5, 80, v9
    v_lshl_add_u32 v5, v10, 4, v5
    v_lshrrev_b32 v9, 4, v0
    v_and_b32 v10, 15, v0
    v_mul_lo_u32 v3, v9, s43
    v_lshl_add_u32 v3, v10, 4, v3
    v_add_u32 v3, s41, v3
    s_mul_i32 s44, s43, 16
    v_add_u32 v4, s44, v3
    v_mul_u32_u24 v6, 272, v9
    v_lshl_add_u32 v6, v10, 4, v6
    v_add_u32 v6, 10240, v6
    v_lshrrev_b32 v9, 6, v0
    v_and_b32 v10, 63, v0
    v_lshrrev_b32 v11, 1, v9
    v_and_b32 v12, 1, v9
    v_and_b32 v9, 15, v10
    v_lshl_add_u32 v9, v11, 6, v9
    v_mul_u32_u24 v7, 80, v9
    v_lshrrev_b32 v9, 4, v10
    v_lshl_add_u32 v7, v9, 4, v7
    v_lshlrev_b32 v9, 3, v9
    v_bfe_u32 v11, v10, 2, 2
    v_add_u32 v9, v9, v11
    v_mul_u32_u24 v8, 272, v9
    v_and_b32 v11, 3, v10
    v_lshl_add_u32 v8, v11, 3, v8
    v_mul_u32_u24 v12, 128, v12
    v_add_u32 v8, v8, v12
    v_add_u32 v8, 10240, v8

    v_mov_b32 v64, 0
    v_mov_b32 v65, 0
    v_mov_b32 v66, 0
    v_mov_b32 v67, 0
    v_mov_b32 v68, 0
    v_mov_b32 v69, 0
    v_mov_b32 v70, 0
    v_mov_b32 v71, 0
    v_mov_b32 v72, 0
    v_mov_b32 v73, 0
    v_mov_b32 v74, 0
    v_mov_b32 v75, 0
    v_mov_b32 v76, 0
    v_mov_b32 v77, 0
    v_mov_b32 v78, 0
    v_mov_b32 v79, 0
    v_mov_b32 v80, 0
    v_mov_b32 v81, 0
    v_mov_b32 v82, 0
    v_mov_b32 v83, 0
    v_mov_b32 v84, 0
    v_mov_b32 v85, 0
    v_mov_b32 v86, 0
    v_mov_b32 v87, 0
    v_mov_b32 v88, 0
    v_mov_b32 v89, 0
    v_mov_b32 v90, 0
    v_mov_b32 v91, 0
    v_mov_b32 v92, 0
    v_mov_b32 v93, 0
    v_mov_b32 v94, 0
    v_mov_b32 v95, 0
    v_mov_b32 v96, 0
    v_mov_b32 v97, 0
    v_mov_b32 v98, 0
    v_mov_b32 v99, 0
    v_mov_b32 v100, 0
    v_mov_b32 v101, 0
    v_mov_b32 v102, 0
    v_mov_b32 v103, 0
    v_mov_b32 v104, 0
    v_mov_b32 v105, 0
    v_mov_b32 v106, 0
    v_mov_b32 v107, 0
    v_mov_b32 v108, 0
    v_mov_b32 v109, 0
    v_mov_b32 v110, 0
    v_mov_b32 v111, 0
    v_mov_b32 v112, 0
    v_mov_b32 v113, 0
    v_mov_b32 v114, 0
    v_mov_b32 v115, 0
    v_mov_b32 v116, 0
    v_mov_b32 v117, 0
    v_mov_b32 v118, 0
    v_mov_b32 v119, 0
    v_mov_b32 v120, 0
    v_mov_b32 v121, 0
    v_mov_b32 v122, 0
    v_mov_b32 v123, 0
    v_mov_b32 v124, 0
    v_mov_b32 v125, 0
    v_mov_b32 v126, 0
    v_mov_b32 v127, 0
    s_mov_b32 s45, 0
    s_mov_b32 s46, 0
    s_mov_b32 s47, 0
    s_mov_b32 s48, 20480
    s_lshl_b32 s50, s43, 5
    s_mov_b32 s49, 32

    buffer_load_dwordx4 v[16:19], v1, s[28:31], s45 offen
    buffer_load_dwordx4 v[20:23], v2, s[28:31], s45 offen
    buffer_load_dwordx4 v[24:27], v3, s[32:35], s46 offen

    buffer_load_dwordx4 v[28:31], v4, s[32:35], s46 offen
    s_waitcnt vmcnt(0)
    v_add_u32 v9, s47, v5
    v_add_u32 v10, s47, v6
    ds_write_b128 v9, v[16:19]
    ds_write_b128 v9, v[20:23] offset:5120
    ds_write_b128 v10, v[24:27]

    ds_write_b128 v10, v[28:31] offset:4352
    s_waitcnt lgkmcnt(0)
    s_barrier
    s_mov_b32 s47, 20480
    s_mov_b32 s48, 0

GL_1:
    s_add_u32 s45, s45, 64
    s_add_u32 s46, s46, s50
    s_sub_u32 s49, s49, 1

    buffer_load_dwordx4 v[16:19], v1, s[28:31], s45 offen
    buffer_load_dwordx4 v[20:23], v2, s[28:31], s45 offen
    buffer_load_dwordx4 v[24:27], v3, s[32:35], s46 offen

    buffer_load_dwordx4 v[28:31], v4, s[32:35], s46 offen
    v_add_u32 v11, s48, v7
    v_add_u32 v12, s48, v8

    ds_read_b128 v[48:51], v11 offset:0
    ds_read_b128 v[52:55], v11 offset:1280
    ds_read_b128 v[56:59], v11 offset:2560
    ds_read_b128 v[60:63], v11 offset:3840
    ds_read_b64_tr_b16 v[32:33], v12 offset:0
    ds_read_b64_tr_b16 v[34:35], v12 offset:1088

    ds_read_b64_tr_b16 v[36:37], v12 offset:32
    ds_read_b64_tr_b16 v[38:39], v12 offset:1120

    ds_read_b64_tr_b16 v[40:41], v12 offset:64
    ds_read_b64_tr_b16 v[42:43], v12 offset:1152

    ds_read_b64_tr_b16 v[44:45], v12 offset:96
    ds_read_b64_tr_b16 v[46:47], v12 offset:1184

    s_waitcnt lgkmcnt(0)
    v_mfma_f32_16x16x32_bf16 v[64:67], v[32:35], v[48:51], v[64:67]
    v_mfma_f32_16x16x32_bf16 v[68:71], v[32:35], v[52:55], v[68:71]
    v_mfma_f32_16x16x32_bf16 v[72:75], v[32:35], v[56:59], v[72:75]
    v_mfma_f32_16x16x32_bf16 v[76:79], v[32:35], v[60:63], v[76:79]
    v_mfma_f32_16x16x32_bf16 v[80:83], v[36:39], v[48:51], v[80:83]
    v_mfma_f32_16x16x32_bf16 v[84:87], v[36:39], v[52:55], v[84:87]
    v_mfma_f32_16x16x32_bf16 v[88:91], v[36:39], v[56:59], v[88:91]
    v_mfma_f32_16x16x32_bf16 v[92:95], v[36:39], v[60:63], v[92:95]
    v_mfma_f32_16x16x32_bf16 v[96:99], v[40:43], v[48:51], v[96:99]
    v_mfma_f32_16x16x32_bf16 v[100:103], v[40:43], v[52:55], v[100:103]
    v_mfma_f32_16x16x32_bf16 v[104:107], v[40:43], v[56:59], v[104:107]
    v_mfma_f32_16x16x32_bf16 v[108:111], v[40:43], v[60:63], v[108:111]
    v_mfma_f32_16x16x32_bf16 v[112:115], v[44:47], v[48:51], v[112:115]
    v_mfma_f32_16x16x32_bf16 v[116:119], v[44:47], v[52:55], v[116:119]
    v_mfma_f32_16x16x32_bf16 v[120:123], v[44:47], v[56:59], v[120:123]
    v_mfma_f32_16x16x32_bf16 v[124:127], v[44:47], v[60:63], v[124:127]
    s_waitcnt vmcnt(0)
    v_add_u32 v9, s47, v5
    v_add_u32 v10, s47, v6
    ds_write_b128 v9, v[16:19]
    ds_write_b128 v9, v[20:23] offset:5120
    ds_write_b128 v10, v[24:27]

    ds_write_b128 v10, v[28:31] offset:4352
    s_waitcnt lgkmcnt(0)
    s_barrier
    s_xor_b32 s47, s47, 20480
    s_xor_b32 s48, s48, 20480
    s_cmp_gt_u32 s49, 0
    s_cbranch_scc1 GL_1

    s_nop 7
    s_nop 7
    v_lshrrev_b32 v9, 6, v0
    v_and_b32 v10, 63, v0
    v_lshrrev_b32 v11, 1, v9
    v_and_b32 v12, 1, v9
    v_and_b32 v1, 15, v10
    v_lshl_add_u32 v1, v11, 6, v1
    v_add_u32 v1, s40, v1
    v_mul_lo_u32 v1, v1, s24
    v_lshrrev_b32 v2, 4, v10
    v_lshlrev_b32 v2, 3, v2
    v_lshl_add_u32 v2, v12, 7, v2
    v_add_u32 v2, s41, v2
    v_add_u32 v1, v1, v2
    v_add_u32 v1, s22, v1
    s_lshl_b32 s25, s24, 4
    s_cmp_eq_u32 s18, 3
    s_cbranch_scc1 K2_EPI_FFN

    v_cvt_pk_bf16_f32 v16, v64, v65
    v_cvt_pk_bf16_f32 v17, v66, v67

    v_cvt_pk_bf16_f32 v18, v80, v81
    v_cvt_pk_bf16_f32 v19, v82, v83

    v_cvt_pk_bf16_f32 v20, v96, v97
    v_cvt_pk_bf16_f32 v21, v98, v99

    v_cvt_pk_bf16_f32 v22, v112, v113
    v_cvt_pk_bf16_f32 v23, v114, v115

    buffer_store_dwordx2 v[16:17], v1, s[28:31], 0 offen offset:0
    buffer_store_dwordx2 v[18:19], v1, s[28:31], 0 offen offset:32
    buffer_store_dwordx2 v[20:21], v1, s[28:31], 0 offen offset:64
    buffer_store_dwordx2 v[22:23], v1, s[28:31], 0 offen offset:96
    v_add_u32 v1, s25, v1
    s_nop 1
    v_cvt_pk_bf16_f32 v16, v68, v69
    v_cvt_pk_bf16_f32 v17, v70, v71

    v_cvt_pk_bf16_f32 v18, v84, v85
    v_cvt_pk_bf16_f32 v19, v86, v87

    v_cvt_pk_bf16_f32 v20, v100, v101
    v_cvt_pk_bf16_f32 v21, v102, v103

    v_cvt_pk_bf16_f32 v22, v116, v117
    v_cvt_pk_bf16_f32 v23, v118, v119

    buffer_store_dwordx2 v[16:17], v1, s[28:31], 0 offen offset:0
    buffer_store_dwordx2 v[18:19], v1, s[28:31], 0 offen offset:32
    buffer_store_dwordx2 v[20:21], v1, s[28:31], 0 offen offset:64
    buffer_store_dwordx2 v[22:23], v1, s[28:31], 0 offen offset:96
    v_add_u32 v1, s25, v1
    s_nop 1
    v_cvt_pk_bf16_f32 v16, v72, v73
    v_cvt_pk_bf16_f32 v17, v74, v75

    v_cvt_pk_bf16_f32 v18, v88, v89
    v_cvt_pk_bf16_f32 v19, v90, v91

    v_cvt_pk_bf16_f32 v20, v104, v105
    v_cvt_pk_bf16_f32 v21, v106, v107

    v_cvt_pk_bf16_f32 v22, v120, v121
    v_cvt_pk_bf16_f32 v23, v122, v123

    buffer_store_dwordx2 v[16:17], v1, s[28:31], 0 offen offset:0
    buffer_store_dwordx2 v[18:19], v1, s[28:31], 0 offen offset:32
    buffer_store_dwordx2 v[20:21], v1, s[28:31], 0 offen offset:64
    buffer_store_dwordx2 v[22:23], v1, s[28:31], 0 offen offset:96
    v_add_u32 v1, s25, v1
    s_nop 1
    v_cvt_pk_bf16_f32 v16, v76, v77
    v_cvt_pk_bf16_f32 v17, v78, v79

    v_cvt_pk_bf16_f32 v18, v92, v93
    v_cvt_pk_bf16_f32 v19, v94, v95

    v_cvt_pk_bf16_f32 v20, v108, v109
    v_cvt_pk_bf16_f32 v21, v110, v111

    v_cvt_pk_bf16_f32 v22, v124, v125
    v_cvt_pk_bf16_f32 v23, v126, v127

    buffer_store_dwordx2 v[16:17], v1, s[28:31], 0 offen offset:0
    buffer_store_dwordx2 v[18:19], v1, s[28:31], 0 offen offset:32
    buffer_store_dwordx2 v[20:21], v1, s[28:31], 0 offen offset:64
    buffer_store_dwordx2 v[22:23], v1, s[28:31], 0 offen offset:96
    v_add_u32 v1, s25, v1
    s_nop 1
    s_branch K2_END
K2_EPI_FFN:
    buffer_load_dwordx2 v[16:17], v2, s[36:39], 0 offen offset:0
    buffer_load_dwordx2 v[18:19], v2, s[36:39], 0 offen offset:32
    buffer_load_dwordx2 v[20:21], v2, s[36:39], 0 offen offset:64
    buffer_load_dwordx2 v[22:23], v2, s[36:39], 0 offen offset:96
    s_waitcnt vmcnt(0)
    v_lshlrev_b32 v24, 16, v16
    v_and_b32 v25, 0xffff0000, v16
    v_lshlrev_b32 v26, 16, v17
    v_and_b32 v27, 0xffff0000, v17

    v_lshlrev_b32 v28, 16, v18
    v_and_b32 v29, 0xffff0000, v18
    v_lshlrev_b32 v30, 16, v19
    v_and_b32 v31, 0xffff0000, v19

    v_lshlrev_b32 v32, 16, v20
    v_and_b32 v33, 0xffff0000, v20
    v_lshlrev_b32 v34, 16, v21
    v_and_b32 v35, 0xffff0000, v21

    v_lshlrev_b32 v36, 16, v22
    v_and_b32 v37, 0xffff0000, v22
    v_lshlrev_b32 v38, 16, v23
    v_and_b32 v39, 0xffff0000, v23

    s_mov_b32 s26, 0x3f4c422a
    s_mov_b32 s27, 0x3d372713
    s_mov_b32 s51, 0x4038aa3b

    v_cvt_pk_bf16_f32 v9, v64, v65
    v_cvt_pk_bf16_f32 v10, v66, v67
    v_lshlrev_b32 v40, 16, v9
    v_and_b32 v41, 0xffff0000, v9
    v_lshlrev_b32 v42, 16, v10
    v_and_b32 v43, 0xffff0000, v10
    v_add_f32 v40, v40, v24
    v_add_f32 v41, v41, v25
    v_add_f32 v42, v42, v26
    v_add_f32 v43, v43, v27
    v_cvt_pk_bf16_f32 v9, v40, v41
    v_cvt_pk_bf16_f32 v10, v42, v43
    v_lshlrev_b32 v40, 16, v9
    v_and_b32 v41, 0xffff0000, v9
    v_lshlrev_b32 v42, 16, v10
    v_and_b32 v43, 0xffff0000, v10

    v_mul_f32 v44, v40, v40
    v_mul_f32 v44, v44, v40
    v_fma_f32 v44, v44, s27, v40
    v_mul_f32 v44, s26, v44
    v_mul_f32 v44, s51, v44
    v_exp_f32 v44, v44
    s_nop 0
    v_add_f32 v44, 1.0, v44
    v_rcp_f32 v44, v44
    s_nop 0
    v_fma_f32 v44, v44, -2.0, 1.0
    v_add_f32 v44, 1.0, v44
    v_mul_f32 v44, 0.5, v44
    v_mul_f32 v40, v40, v44

    v_mul_f32 v44, v41, v41
    v_mul_f32 v44, v44, v41
    v_fma_f32 v44, v44, s27, v41
    v_mul_f32 v44, s26, v44
    v_mul_f32 v44, s51, v44
    v_exp_f32 v44, v44
    s_nop 0
    v_add_f32 v44, 1.0, v44
    v_rcp_f32 v44, v44
    s_nop 0
    v_fma_f32 v44, v44, -2.0, 1.0
    v_add_f32 v44, 1.0, v44
    v_mul_f32 v44, 0.5, v44
    v_mul_f32 v41, v41, v44

    v_mul_f32 v44, v42, v42
    v_mul_f32 v44, v44, v42
    v_fma_f32 v44, v44, s27, v42
    v_mul_f32 v44, s26, v44
    v_mul_f32 v44, s51, v44
    v_exp_f32 v44, v44
    s_nop 0
    v_add_f32 v44, 1.0, v44
    v_rcp_f32 v44, v44
    s_nop 0
    v_fma_f32 v44, v44, -2.0, 1.0
    v_add_f32 v44, 1.0, v44
    v_mul_f32 v44, 0.5, v44
    v_mul_f32 v42, v42, v44

    v_mul_f32 v44, v43, v43
    v_mul_f32 v44, v44, v43
    v_fma_f32 v44, v44, s27, v43
    v_mul_f32 v44, s26, v44
    v_mul_f32 v44, s51, v44
    v_exp_f32 v44, v44
    s_nop 0
    v_add_f32 v44, 1.0, v44
    v_rcp_f32 v44, v44
    s_nop 0
    v_fma_f32 v44, v44, -2.0, 1.0
    v_add_f32 v44, 1.0, v44
    v_mul_f32 v44, 0.5, v44
    v_mul_f32 v43, v43, v44

    v_cvt_pk_bf16_f32 v16, v40, v41
    v_cvt_pk_bf16_f32 v17, v42, v43

    v_cvt_pk_bf16_f32 v9, v80, v81
    v_cvt_pk_bf16_f32 v10, v82, v83
    v_lshlrev_b32 v40, 16, v9
    v_and_b32 v41, 0xffff0000, v9
    v_lshlrev_b32 v42, 16, v10
    v_and_b32 v43, 0xffff0000, v10
    v_add_f32 v40, v40, v28
    v_add_f32 v41, v41, v29
    v_add_f32 v42, v42, v30
    v_add_f32 v43, v43, v31
    v_cvt_pk_bf16_f32 v9, v40, v41
    v_cvt_pk_bf16_f32 v10, v42, v43
    v_lshlrev_b32 v40, 16, v9
    v_and_b32 v41, 0xffff0000, v9
    v_lshlrev_b32 v42, 16, v10
    v_and_b32 v43, 0xffff0000, v10

    v_mul_f32 v44, v40, v40
    v_mul_f32 v44, v44, v40
    v_fma_f32 v44, v44, s27, v40
    v_mul_f32 v44, s26, v44
    v_mul_f32 v44, s51, v44
    v_exp_f32 v44, v44
    s_nop 0
    v_add_f32 v44, 1.0, v44
    v_rcp_f32 v44, v44
    s_nop 0
    v_fma_f32 v44, v44, -2.0, 1.0
    v_add_f32 v44, 1.0, v44
    v_mul_f32 v44, 0.5, v44
    v_mul_f32 v40, v40, v44

    v_mul_f32 v44, v41, v41
    v_mul_f32 v44, v44, v41
    v_fma_f32 v44, v44, s27, v41
    v_mul_f32 v44, s26, v44
    v_mul_f32 v44, s51, v44
    v_exp_f32 v44, v44
    s_nop 0
    v_add_f32 v44, 1.0, v44
    v_rcp_f32 v44, v44
    s_nop 0
    v_fma_f32 v44, v44, -2.0, 1.0
    v_add_f32 v44, 1.0, v44
    v_mul_f32 v44, 0.5, v44
    v_mul_f32 v41, v41, v44

    v_mul_f32 v44, v42, v42
    v_mul_f32 v44, v44, v42
    v_fma_f32 v44, v44, s27, v42
    v_mul_f32 v44, s26, v44
    v_mul_f32 v44, s51, v44
    v_exp_f32 v44, v44
    s_nop 0
    v_add_f32 v44, 1.0, v44
    v_rcp_f32 v44, v44
    s_nop 0
    v_fma_f32 v44, v44, -2.0, 1.0
    v_add_f32 v44, 1.0, v44
    v_mul_f32 v44, 0.5, v44
    v_mul_f32 v42, v42, v44

    v_mul_f32 v44, v43, v43
    v_mul_f32 v44, v44, v43
    v_fma_f32 v44, v44, s27, v43
    v_mul_f32 v44, s26, v44
    v_mul_f32 v44, s51, v44
    v_exp_f32 v44, v44
    s_nop 0
    v_add_f32 v44, 1.0, v44
    v_rcp_f32 v44, v44
    s_nop 0
    v_fma_f32 v44, v44, -2.0, 1.0
    v_add_f32 v44, 1.0, v44
    v_mul_f32 v44, 0.5, v44
    v_mul_f32 v43, v43, v44

    v_cvt_pk_bf16_f32 v18, v40, v41
    v_cvt_pk_bf16_f32 v19, v42, v43

    v_cvt_pk_bf16_f32 v9, v96, v97
    v_cvt_pk_bf16_f32 v10, v98, v99
    v_lshlrev_b32 v40, 16, v9
    v_and_b32 v41, 0xffff0000, v9
    v_lshlrev_b32 v42, 16, v10
    v_and_b32 v43, 0xffff0000, v10
    v_add_f32 v40, v40, v32
    v_add_f32 v41, v41, v33
    v_add_f32 v42, v42, v34
    v_add_f32 v43, v43, v35
    v_cvt_pk_bf16_f32 v9, v40, v41
    v_cvt_pk_bf16_f32 v10, v42, v43
    v_lshlrev_b32 v40, 16, v9
    v_and_b32 v41, 0xffff0000, v9
    v_lshlrev_b32 v42, 16, v10
    v_and_b32 v43, 0xffff0000, v10

    v_mul_f32 v44, v40, v40
    v_mul_f32 v44, v44, v40
    v_fma_f32 v44, v44, s27, v40
    v_mul_f32 v44, s26, v44
    v_mul_f32 v44, s51, v44
    v_exp_f32 v44, v44
    s_nop 0
    v_add_f32 v44, 1.0, v44
    v_rcp_f32 v44, v44
    s_nop 0
    v_fma_f32 v44, v44, -2.0, 1.0
    v_add_f32 v44, 1.0, v44
    v_mul_f32 v44, 0.5, v44
    v_mul_f32 v40, v40, v44

    v_mul_f32 v44, v41, v41
    v_mul_f32 v44, v44, v41
    v_fma_f32 v44, v44, s27, v41
    v_mul_f32 v44, s26, v44
    v_mul_f32 v44, s51, v44
    v_exp_f32 v44, v44
    s_nop 0
    v_add_f32 v44, 1.0, v44
    v_rcp_f32 v44, v44
    s_nop 0
    v_fma_f32 v44, v44, -2.0, 1.0
    v_add_f32 v44, 1.0, v44
    v_mul_f32 v44, 0.5, v44
    v_mul_f32 v41, v41, v44

    v_mul_f32 v44, v42, v42
    v_mul_f32 v44, v44, v42
    v_fma_f32 v44, v44, s27, v42
    v_mul_f32 v44, s26, v44
    v_mul_f32 v44, s51, v44
    v_exp_f32 v44, v44
    s_nop 0
    v_add_f32 v44, 1.0, v44
    v_rcp_f32 v44, v44
    s_nop 0
    v_fma_f32 v44, v44, -2.0, 1.0
    v_add_f32 v44, 1.0, v44
    v_mul_f32 v44, 0.5, v44
    v_mul_f32 v42, v42, v44

    v_mul_f32 v44, v43, v43
    v_mul_f32 v44, v44, v43
    v_fma_f32 v44, v44, s27, v43
    v_mul_f32 v44, s26, v44
    v_mul_f32 v44, s51, v44
    v_exp_f32 v44, v44
    s_nop 0
    v_add_f32 v44, 1.0, v44
    v_rcp_f32 v44, v44
    s_nop 0
    v_fma_f32 v44, v44, -2.0, 1.0
    v_add_f32 v44, 1.0, v44
    v_mul_f32 v44, 0.5, v44
    v_mul_f32 v43, v43, v44

    v_cvt_pk_bf16_f32 v20, v40, v41
    v_cvt_pk_bf16_f32 v21, v42, v43

    v_cvt_pk_bf16_f32 v9, v112, v113
    v_cvt_pk_bf16_f32 v10, v114, v115
    v_lshlrev_b32 v40, 16, v9
    v_and_b32 v41, 0xffff0000, v9
    v_lshlrev_b32 v42, 16, v10
    v_and_b32 v43, 0xffff0000, v10
    v_add_f32 v40, v40, v36
    v_add_f32 v41, v41, v37
    v_add_f32 v42, v42, v38
    v_add_f32 v43, v43, v39
    v_cvt_pk_bf16_f32 v9, v40, v41
    v_cvt_pk_bf16_f32 v10, v42, v43
    v_lshlrev_b32 v40, 16, v9
    v_and_b32 v41, 0xffff0000, v9
    v_lshlrev_b32 v42, 16, v10
    v_and_b32 v43, 0xffff0000, v10

    v_mul_f32 v44, v40, v40
    v_mul_f32 v44, v44, v40
    v_fma_f32 v44, v44, s27, v40
    v_mul_f32 v44, s26, v44
    v_mul_f32 v44, s51, v44
    v_exp_f32 v44, v44
    s_nop 0
    v_add_f32 v44, 1.0, v44
    v_rcp_f32 v44, v44
    s_nop 0
    v_fma_f32 v44, v44, -2.0, 1.0
    v_add_f32 v44, 1.0, v44
    v_mul_f32 v44, 0.5, v44
    v_mul_f32 v40, v40, v44

    v_mul_f32 v44, v41, v41
    v_mul_f32 v44, v44, v41
    v_fma_f32 v44, v44, s27, v41
    v_mul_f32 v44, s26, v44
    v_mul_f32 v44, s51, v44
    v_exp_f32 v44, v44
    s_nop 0
    v_add_f32 v44, 1.0, v44
    v_rcp_f32 v44, v44
    s_nop 0
    v_fma_f32 v44, v44, -2.0, 1.0
    v_add_f32 v44, 1.0, v44
    v_mul_f32 v44, 0.5, v44
    v_mul_f32 v41, v41, v44

    v_mul_f32 v44, v42, v42
    v_mul_f32 v44, v44, v42
    v_fma_f32 v44, v44, s27, v42
    v_mul_f32 v44, s26, v44
    v_mul_f32 v44, s51, v44
    v_exp_f32 v44, v44
    s_nop 0
    v_add_f32 v44, 1.0, v44
    v_rcp_f32 v44, v44
    s_nop 0
    v_fma_f32 v44, v44, -2.0, 1.0
    v_add_f32 v44, 1.0, v44
    v_mul_f32 v44, 0.5, v44
    v_mul_f32 v42, v42, v44

    v_mul_f32 v44, v43, v43
    v_mul_f32 v44, v44, v43
    v_fma_f32 v44, v44, s27, v43
    v_mul_f32 v44, s26, v44
    v_mul_f32 v44, s51, v44
    v_exp_f32 v44, v44
    s_nop 0
    v_add_f32 v44, 1.0, v44
    v_rcp_f32 v44, v44
    s_nop 0
    v_fma_f32 v44, v44, -2.0, 1.0
    v_add_f32 v44, 1.0, v44
    v_mul_f32 v44, 0.5, v44
    v_mul_f32 v43, v43, v44

    v_cvt_pk_bf16_f32 v22, v40, v41
    v_cvt_pk_bf16_f32 v23, v42, v43

    buffer_store_dwordx2 v[16:17], v1, s[28:31], 0 offen offset:0
    buffer_store_dwordx2 v[18:19], v1, s[28:31], 0 offen offset:32
    buffer_store_dwordx2 v[20:21], v1, s[28:31], 0 offen offset:64
    buffer_store_dwordx2 v[22:23], v1, s[28:31], 0 offen offset:96
    v_add_u32 v1, s25, v1
    s_nop 1
    v_cvt_pk_bf16_f32 v9, v68, v69
    v_cvt_pk_bf16_f32 v10, v70, v71
    v_lshlrev_b32 v40, 16, v9
    v_and_b32 v41, 0xffff0000, v9
    v_lshlrev_b32 v42, 16, v10
    v_and_b32 v43, 0xffff0000, v10
    v_add_f32 v40, v40, v24
    v_add_f32 v41, v41, v25
    v_add_f32 v42, v42, v26
    v_add_f32 v43, v43, v27
    v_cvt_pk_bf16_f32 v9, v40, v41
    v_cvt_pk_bf16_f32 v10, v42, v43
    v_lshlrev_b32 v40, 16, v9
    v_and_b32 v41, 0xffff0000, v9
    v_lshlrev_b32 v42, 16, v10
    v_and_b32 v43, 0xffff0000, v10

    v_mul_f32 v44, v40, v40
    v_mul_f32 v44, v44, v40
    v_fma_f32 v44, v44, s27, v40
    v_mul_f32 v44, s26, v44
    v_mul_f32 v44, s51, v44
    v_exp_f32 v44, v44
    s_nop 0
    v_add_f32 v44, 1.0, v44
    v_rcp_f32 v44, v44
    s_nop 0
    v_fma_f32 v44, v44, -2.0, 1.0
    v_add_f32 v44, 1.0, v44
    v_mul_f32 v44, 0.5, v44
    v_mul_f32 v40, v40, v44

    v_mul_f32 v44, v41, v41
    v_mul_f32 v44, v44, v41
    v_fma_f32 v44, v44, s27, v41
    v_mul_f32 v44, s26, v44
    v_mul_f32 v44, s51, v44
    v_exp_f32 v44, v44
    s_nop 0
    v_add_f32 v44, 1.0, v44
    v_rcp_f32 v44, v44
    s_nop 0
    v_fma_f32 v44, v44, -2.0, 1.0
    v_add_f32 v44, 1.0, v44
    v_mul_f32 v44, 0.5, v44
    v_mul_f32 v41, v41, v44

    v_mul_f32 v44, v42, v42
    v_mul_f32 v44, v44, v42
    v_fma_f32 v44, v44, s27, v42
    v_mul_f32 v44, s26, v44
    v_mul_f32 v44, s51, v44
    v_exp_f32 v44, v44
    s_nop 0
    v_add_f32 v44, 1.0, v44
    v_rcp_f32 v44, v44
    s_nop 0
    v_fma_f32 v44, v44, -2.0, 1.0
    v_add_f32 v44, 1.0, v44
    v_mul_f32 v44, 0.5, v44
    v_mul_f32 v42, v42, v44

    v_mul_f32 v44, v43, v43
    v_mul_f32 v44, v44, v43
    v_fma_f32 v44, v44, s27, v43
    v_mul_f32 v44, s26, v44
    v_mul_f32 v44, s51, v44
    v_exp_f32 v44, v44
    s_nop 0
    v_add_f32 v44, 1.0, v44
    v_rcp_f32 v44, v44
    s_nop 0
    v_fma_f32 v44, v44, -2.0, 1.0
    v_add_f32 v44, 1.0, v44
    v_mul_f32 v44, 0.5, v44
    v_mul_f32 v43, v43, v44

    v_cvt_pk_bf16_f32 v16, v40, v41
    v_cvt_pk_bf16_f32 v17, v42, v43

    v_cvt_pk_bf16_f32 v9, v84, v85
    v_cvt_pk_bf16_f32 v10, v86, v87
    v_lshlrev_b32 v40, 16, v9
    v_and_b32 v41, 0xffff0000, v9
    v_lshlrev_b32 v42, 16, v10
    v_and_b32 v43, 0xffff0000, v10
    v_add_f32 v40, v40, v28
    v_add_f32 v41, v41, v29
    v_add_f32 v42, v42, v30
    v_add_f32 v43, v43, v31
    v_cvt_pk_bf16_f32 v9, v40, v41
    v_cvt_pk_bf16_f32 v10, v42, v43
    v_lshlrev_b32 v40, 16, v9
    v_and_b32 v41, 0xffff0000, v9
    v_lshlrev_b32 v42, 16, v10
    v_and_b32 v43, 0xffff0000, v10

    v_mul_f32 v44, v40, v40
    v_mul_f32 v44, v44, v40
    v_fma_f32 v44, v44, s27, v40
    v_mul_f32 v44, s26, v44
    v_mul_f32 v44, s51, v44
    v_exp_f32 v44, v44
    s_nop 0
    v_add_f32 v44, 1.0, v44
    v_rcp_f32 v44, v44
    s_nop 0
    v_fma_f32 v44, v44, -2.0, 1.0
    v_add_f32 v44, 1.0, v44
    v_mul_f32 v44, 0.5, v44
    v_mul_f32 v40, v40, v44

    v_mul_f32 v44, v41, v41
    v_mul_f32 v44, v44, v41
    v_fma_f32 v44, v44, s27, v41
    v_mul_f32 v44, s26, v44
    v_mul_f32 v44, s51, v44
    v_exp_f32 v44, v44
    s_nop 0
    v_add_f32 v44, 1.0, v44
    v_rcp_f32 v44, v44
    s_nop 0
    v_fma_f32 v44, v44, -2.0, 1.0
    v_add_f32 v44, 1.0, v44
    v_mul_f32 v44, 0.5, v44
    v_mul_f32 v41, v41, v44

    v_mul_f32 v44, v42, v42
    v_mul_f32 v44, v44, v42
    v_fma_f32 v44, v44, s27, v42
    v_mul_f32 v44, s26, v44
    v_mul_f32 v44, s51, v44
    v_exp_f32 v44, v44
    s_nop 0
    v_add_f32 v44, 1.0, v44
    v_rcp_f32 v44, v44
    s_nop 0
    v_fma_f32 v44, v44, -2.0, 1.0
    v_add_f32 v44, 1.0, v44
    v_mul_f32 v44, 0.5, v44
    v_mul_f32 v42, v42, v44

    v_mul_f32 v44, v43, v43
    v_mul_f32 v44, v44, v43
    v_fma_f32 v44, v44, s27, v43
    v_mul_f32 v44, s26, v44
    v_mul_f32 v44, s51, v44
    v_exp_f32 v44, v44
    s_nop 0
    v_add_f32 v44, 1.0, v44
    v_rcp_f32 v44, v44
    s_nop 0
    v_fma_f32 v44, v44, -2.0, 1.0
    v_add_f32 v44, 1.0, v44
    v_mul_f32 v44, 0.5, v44
    v_mul_f32 v43, v43, v44

    v_cvt_pk_bf16_f32 v18, v40, v41
    v_cvt_pk_bf16_f32 v19, v42, v43

    v_cvt_pk_bf16_f32 v9, v100, v101
    v_cvt_pk_bf16_f32 v10, v102, v103
    v_lshlrev_b32 v40, 16, v9
    v_and_b32 v41, 0xffff0000, v9
    v_lshlrev_b32 v42, 16, v10
    v_and_b32 v43, 0xffff0000, v10
    v_add_f32 v40, v40, v32
    v_add_f32 v41, v41, v33
    v_add_f32 v42, v42, v34
    v_add_f32 v43, v43, v35
    v_cvt_pk_bf16_f32 v9, v40, v41
    v_cvt_pk_bf16_f32 v10, v42, v43
    v_lshlrev_b32 v40, 16, v9
    v_and_b32 v41, 0xffff0000, v9
    v_lshlrev_b32 v42, 16, v10
    v_and_b32 v43, 0xffff0000, v10

    v_mul_f32 v44, v40, v40
    v_mul_f32 v44, v44, v40
    v_fma_f32 v44, v44, s27, v40
    v_mul_f32 v44, s26, v44
    v_mul_f32 v44, s51, v44
    v_exp_f32 v44, v44
    s_nop 0
    v_add_f32 v44, 1.0, v44
    v_rcp_f32 v44, v44
    s_nop 0
    v_fma_f32 v44, v44, -2.0, 1.0
    v_add_f32 v44, 1.0, v44
    v_mul_f32 v44, 0.5, v44
    v_mul_f32 v40, v40, v44

    v_mul_f32 v44, v41, v41
    v_mul_f32 v44, v44, v41
    v_fma_f32 v44, v44, s27, v41
    v_mul_f32 v44, s26, v44
    v_mul_f32 v44, s51, v44
    v_exp_f32 v44, v44
    s_nop 0
    v_add_f32 v44, 1.0, v44
    v_rcp_f32 v44, v44
    s_nop 0
    v_fma_f32 v44, v44, -2.0, 1.0
    v_add_f32 v44, 1.0, v44
    v_mul_f32 v44, 0.5, v44
    v_mul_f32 v41, v41, v44

    v_mul_f32 v44, v42, v42
    v_mul_f32 v44, v44, v42
    v_fma_f32 v44, v44, s27, v42
    v_mul_f32 v44, s26, v44
    v_mul_f32 v44, s51, v44
    v_exp_f32 v44, v44
    s_nop 0
    v_add_f32 v44, 1.0, v44
    v_rcp_f32 v44, v44
    s_nop 0
    v_fma_f32 v44, v44, -2.0, 1.0
    v_add_f32 v44, 1.0, v44
    v_mul_f32 v44, 0.5, v44
    v_mul_f32 v42, v42, v44

    v_mul_f32 v44, v43, v43
    v_mul_f32 v44, v44, v43
    v_fma_f32 v44, v44, s27, v43
    v_mul_f32 v44, s26, v44
    v_mul_f32 v44, s51, v44
    v_exp_f32 v44, v44
    s_nop 0
    v_add_f32 v44, 1.0, v44
    v_rcp_f32 v44, v44
    s_nop 0
    v_fma_f32 v44, v44, -2.0, 1.0
    v_add_f32 v44, 1.0, v44
    v_mul_f32 v44, 0.5, v44
    v_mul_f32 v43, v43, v44

    v_cvt_pk_bf16_f32 v20, v40, v41
    v_cvt_pk_bf16_f32 v21, v42, v43

    v_cvt_pk_bf16_f32 v9, v116, v117
    v_cvt_pk_bf16_f32 v10, v118, v119
    v_lshlrev_b32 v40, 16, v9
    v_and_b32 v41, 0xffff0000, v9
    v_lshlrev_b32 v42, 16, v10
    v_and_b32 v43, 0xffff0000, v10
    v_add_f32 v40, v40, v36
    v_add_f32 v41, v41, v37
    v_add_f32 v42, v42, v38
    v_add_f32 v43, v43, v39
    v_cvt_pk_bf16_f32 v9, v40, v41
    v_cvt_pk_bf16_f32 v10, v42, v43
    v_lshlrev_b32 v40, 16, v9
    v_and_b32 v41, 0xffff0000, v9
    v_lshlrev_b32 v42, 16, v10
    v_and_b32 v43, 0xffff0000, v10

    v_mul_f32 v44, v40, v40
    v_mul_f32 v44, v44, v40
    v_fma_f32 v44, v44, s27, v40
    v_mul_f32 v44, s26, v44
    v_mul_f32 v44, s51, v44
    v_exp_f32 v44, v44
    s_nop 0
    v_add_f32 v44, 1.0, v44
    v_rcp_f32 v44, v44
    s_nop 0
    v_fma_f32 v44, v44, -2.0, 1.0
    v_add_f32 v44, 1.0, v44
    v_mul_f32 v44, 0.5, v44
    v_mul_f32 v40, v40, v44

    v_mul_f32 v44, v41, v41
    v_mul_f32 v44, v44, v41
    v_fma_f32 v44, v44, s27, v41
    v_mul_f32 v44, s26, v44
    v_mul_f32 v44, s51, v44
    v_exp_f32 v44, v44
    s_nop 0
    v_add_f32 v44, 1.0, v44
    v_rcp_f32 v44, v44
    s_nop 0
    v_fma_f32 v44, v44, -2.0, 1.0
    v_add_f32 v44, 1.0, v44
    v_mul_f32 v44, 0.5, v44
    v_mul_f32 v41, v41, v44

    v_mul_f32 v44, v42, v42
    v_mul_f32 v44, v44, v42
    v_fma_f32 v44, v44, s27, v42
    v_mul_f32 v44, s26, v44
    v_mul_f32 v44, s51, v44
    v_exp_f32 v44, v44
    s_nop 0
    v_add_f32 v44, 1.0, v44
    v_rcp_f32 v44, v44
    s_nop 0
    v_fma_f32 v44, v44, -2.0, 1.0
    v_add_f32 v44, 1.0, v44
    v_mul_f32 v44, 0.5, v44
    v_mul_f32 v42, v42, v44

    v_mul_f32 v44, v43, v43
    v_mul_f32 v44, v44, v43
    v_fma_f32 v44, v44, s27, v43
    v_mul_f32 v44, s26, v44
    v_mul_f32 v44, s51, v44
    v_exp_f32 v44, v44
    s_nop 0
    v_add_f32 v44, 1.0, v44
    v_rcp_f32 v44, v44
    s_nop 0
    v_fma_f32 v44, v44, -2.0, 1.0
    v_add_f32 v44, 1.0, v44
    v_mul_f32 v44, 0.5, v44
    v_mul_f32 v43, v43, v44

    v_cvt_pk_bf16_f32 v22, v40, v41
    v_cvt_pk_bf16_f32 v23, v42, v43

    buffer_store_dwordx2 v[16:17], v1, s[28:31], 0 offen offset:0
    buffer_store_dwordx2 v[18:19], v1, s[28:31], 0 offen offset:32
    buffer_store_dwordx2 v[20:21], v1, s[28:31], 0 offen offset:64
    buffer_store_dwordx2 v[22:23], v1, s[28:31], 0 offen offset:96
    v_add_u32 v1, s25, v1
    s_nop 1
    v_cvt_pk_bf16_f32 v9, v72, v73
    v_cvt_pk_bf16_f32 v10, v74, v75
    v_lshlrev_b32 v40, 16, v9
    v_and_b32 v41, 0xffff0000, v9
    v_lshlrev_b32 v42, 16, v10
    v_and_b32 v43, 0xffff0000, v10
    v_add_f32 v40, v40, v24
    v_add_f32 v41, v41, v25
    v_add_f32 v42, v42, v26
    v_add_f32 v43, v43, v27
    v_cvt_pk_bf16_f32 v9, v40, v41
    v_cvt_pk_bf16_f32 v10, v42, v43
    v_lshlrev_b32 v40, 16, v9
    v_and_b32 v41, 0xffff0000, v9
    v_lshlrev_b32 v42, 16, v10
    v_and_b32 v43, 0xffff0000, v10

    v_mul_f32 v44, v40, v40
    v_mul_f32 v44, v44, v40
    v_fma_f32 v44, v44, s27, v40
    v_mul_f32 v44, s26, v44
    v_mul_f32 v44, s51, v44
    v_exp_f32 v44, v44
    s_nop 0
    v_add_f32 v44, 1.0, v44
    v_rcp_f32 v44, v44
    s_nop 0
    v_fma_f32 v44, v44, -2.0, 1.0
    v_add_f32 v44, 1.0, v44
    v_mul_f32 v44, 0.5, v44
    v_mul_f32 v40, v40, v44

    v_mul_f32 v44, v41, v41
    v_mul_f32 v44, v44, v41
    v_fma_f32 v44, v44, s27, v41
    v_mul_f32 v44, s26, v44
    v_mul_f32 v44, s51, v44
    v_exp_f32 v44, v44
    s_nop 0
    v_add_f32 v44, 1.0, v44
    v_rcp_f32 v44, v44
    s_nop 0
    v_fma_f32 v44, v44, -2.0, 1.0
    v_add_f32 v44, 1.0, v44
    v_mul_f32 v44, 0.5, v44
    v_mul_f32 v41, v41, v44

    v_mul_f32 v44, v42, v42
    v_mul_f32 v44, v44, v42
    v_fma_f32 v44, v44, s27, v42
    v_mul_f32 v44, s26, v44
    v_mul_f32 v44, s51, v44
    v_exp_f32 v44, v44
    s_nop 0
    v_add_f32 v44, 1.0, v44
    v_rcp_f32 v44, v44
    s_nop 0
    v_fma_f32 v44, v44, -2.0, 1.0
    v_add_f32 v44, 1.0, v44
    v_mul_f32 v44, 0.5, v44
    v_mul_f32 v42, v42, v44

    v_mul_f32 v44, v43, v43
    v_mul_f32 v44, v44, v43
    v_fma_f32 v44, v44, s27, v43
    v_mul_f32 v44, s26, v44
    v_mul_f32 v44, s51, v44
    v_exp_f32 v44, v44
    s_nop 0
    v_add_f32 v44, 1.0, v44
    v_rcp_f32 v44, v44
    s_nop 0
    v_fma_f32 v44, v44, -2.0, 1.0
    v_add_f32 v44, 1.0, v44
    v_mul_f32 v44, 0.5, v44
    v_mul_f32 v43, v43, v44

    v_cvt_pk_bf16_f32 v16, v40, v41
    v_cvt_pk_bf16_f32 v17, v42, v43

    v_cvt_pk_bf16_f32 v9, v88, v89
    v_cvt_pk_bf16_f32 v10, v90, v91
    v_lshlrev_b32 v40, 16, v9
    v_and_b32 v41, 0xffff0000, v9
    v_lshlrev_b32 v42, 16, v10
    v_and_b32 v43, 0xffff0000, v10
    v_add_f32 v40, v40, v28
    v_add_f32 v41, v41, v29
    v_add_f32 v42, v42, v30
    v_add_f32 v43, v43, v31
    v_cvt_pk_bf16_f32 v9, v40, v41
    v_cvt_pk_bf16_f32 v10, v42, v43
    v_lshlrev_b32 v40, 16, v9
    v_and_b32 v41, 0xffff0000, v9
    v_lshlrev_b32 v42, 16, v10
    v_and_b32 v43, 0xffff0000, v10

    v_mul_f32 v44, v40, v40
    v_mul_f32 v44, v44, v40
    v_fma_f32 v44, v44, s27, v40
    v_mul_f32 v44, s26, v44
    v_mul_f32 v44, s51, v44
    v_exp_f32 v44, v44
    s_nop 0
    v_add_f32 v44, 1.0, v44
    v_rcp_f32 v44, v44
    s_nop 0
    v_fma_f32 v44, v44, -2.0, 1.0
    v_add_f32 v44, 1.0, v44
    v_mul_f32 v44, 0.5, v44
    v_mul_f32 v40, v40, v44

    v_mul_f32 v44, v41, v41
    v_mul_f32 v44, v44, v41
    v_fma_f32 v44, v44, s27, v41
    v_mul_f32 v44, s26, v44
    v_mul_f32 v44, s51, v44
    v_exp_f32 v44, v44
    s_nop 0
    v_add_f32 v44, 1.0, v44
    v_rcp_f32 v44, v44
    s_nop 0
    v_fma_f32 v44, v44, -2.0, 1.0
    v_add_f32 v44, 1.0, v44
    v_mul_f32 v44, 0.5, v44
    v_mul_f32 v41, v41, v44

    v_mul_f32 v44, v42, v42
    v_mul_f32 v44, v44, v42
    v_fma_f32 v44, v44, s27, v42
    v_mul_f32 v44, s26, v44
    v_mul_f32 v44, s51, v44
    v_exp_f32 v44, v44
    s_nop 0
    v_add_f32 v44, 1.0, v44
    v_rcp_f32 v44, v44
    s_nop 0
    v_fma_f32 v44, v44, -2.0, 1.0
    v_add_f32 v44, 1.0, v44
    v_mul_f32 v44, 0.5, v44
    v_mul_f32 v42, v42, v44

    v_mul_f32 v44, v43, v43
    v_mul_f32 v44, v44, v43
    v_fma_f32 v44, v44, s27, v43
    v_mul_f32 v44, s26, v44
    v_mul_f32 v44, s51, v44
    v_exp_f32 v44, v44
    s_nop 0
    v_add_f32 v44, 1.0, v44
    v_rcp_f32 v44, v44
    s_nop 0
    v_fma_f32 v44, v44, -2.0, 1.0
    v_add_f32 v44, 1.0, v44
    v_mul_f32 v44, 0.5, v44
    v_mul_f32 v43, v43, v44

    v_cvt_pk_bf16_f32 v18, v40, v41
    v_cvt_pk_bf16_f32 v19, v42, v43

    v_cvt_pk_bf16_f32 v9, v104, v105
    v_cvt_pk_bf16_f32 v10, v106, v107
    v_lshlrev_b32 v40, 16, v9
    v_and_b32 v41, 0xffff0000, v9
    v_lshlrev_b32 v42, 16, v10
    v_and_b32 v43, 0xffff0000, v10
    v_add_f32 v40, v40, v32
    v_add_f32 v41, v41, v33
    v_add_f32 v42, v42, v34
    v_add_f32 v43, v43, v35
    v_cvt_pk_bf16_f32 v9, v40, v41
    v_cvt_pk_bf16_f32 v10, v42, v43
    v_lshlrev_b32 v40, 16, v9
    v_and_b32 v41, 0xffff0000, v9
    v_lshlrev_b32 v42, 16, v10
    v_and_b32 v43, 0xffff0000, v10

    v_mul_f32 v44, v40, v40
    v_mul_f32 v44, v44, v40
    v_fma_f32 v44, v44, s27, v40
    v_mul_f32 v44, s26, v44
    v_mul_f32 v44, s51, v44
    v_exp_f32 v44, v44
    s_nop 0
    v_add_f32 v44, 1.0, v44
    v_rcp_f32 v44, v44
    s_nop 0
    v_fma_f32 v44, v44, -2.0, 1.0
    v_add_f32 v44, 1.0, v44
    v_mul_f32 v44, 0.5, v44
    v_mul_f32 v40, v40, v44

    v_mul_f32 v44, v41, v41
    v_mul_f32 v44, v44, v41
    v_fma_f32 v44, v44, s27, v41
    v_mul_f32 v44, s26, v44
    v_mul_f32 v44, s51, v44
    v_exp_f32 v44, v44
    s_nop 0
    v_add_f32 v44, 1.0, v44
    v_rcp_f32 v44, v44
    s_nop 0
    v_fma_f32 v44, v44, -2.0, 1.0
    v_add_f32 v44, 1.0, v44
    v_mul_f32 v44, 0.5, v44
    v_mul_f32 v41, v41, v44

    v_mul_f32 v44, v42, v42
    v_mul_f32 v44, v44, v42
    v_fma_f32 v44, v44, s27, v42
    v_mul_f32 v44, s26, v44
    v_mul_f32 v44, s51, v44
    v_exp_f32 v44, v44
    s_nop 0
    v_add_f32 v44, 1.0, v44
    v_rcp_f32 v44, v44
    s_nop 0
    v_fma_f32 v44, v44, -2.0, 1.0
    v_add_f32 v44, 1.0, v44
    v_mul_f32 v44, 0.5, v44
    v_mul_f32 v42, v42, v44

    v_mul_f32 v44, v43, v43
    v_mul_f32 v44, v44, v43
    v_fma_f32 v44, v44, s27, v43
    v_mul_f32 v44, s26, v44
    v_mul_f32 v44, s51, v44
    v_exp_f32 v44, v44
    s_nop 0
    v_add_f32 v44, 1.0, v44
    v_rcp_f32 v44, v44
    s_nop 0
    v_fma_f32 v44, v44, -2.0, 1.0
    v_add_f32 v44, 1.0, v44
    v_mul_f32 v44, 0.5, v44
    v_mul_f32 v43, v43, v44

    v_cvt_pk_bf16_f32 v20, v40, v41
    v_cvt_pk_bf16_f32 v21, v42, v43

    v_cvt_pk_bf16_f32 v9, v120, v121
    v_cvt_pk_bf16_f32 v10, v122, v123
    v_lshlrev_b32 v40, 16, v9
    v_and_b32 v41, 0xffff0000, v9
    v_lshlrev_b32 v42, 16, v10
    v_and_b32 v43, 0xffff0000, v10
    v_add_f32 v40, v40, v36
    v_add_f32 v41, v41, v37
    v_add_f32 v42, v42, v38
    v_add_f32 v43, v43, v39
    v_cvt_pk_bf16_f32 v9, v40, v41
    v_cvt_pk_bf16_f32 v10, v42, v43
    v_lshlrev_b32 v40, 16, v9
    v_and_b32 v41, 0xffff0000, v9
    v_lshlrev_b32 v42, 16, v10
    v_and_b32 v43, 0xffff0000, v10

    v_mul_f32 v44, v40, v40
    v_mul_f32 v44, v44, v40
    v_fma_f32 v44, v44, s27, v40
    v_mul_f32 v44, s26, v44
    v_mul_f32 v44, s51, v44
    v_exp_f32 v44, v44
    s_nop 0
    v_add_f32 v44, 1.0, v44
    v_rcp_f32 v44, v44
    s_nop 0
    v_fma_f32 v44, v44, -2.0, 1.0
    v_add_f32 v44, 1.0, v44
    v_mul_f32 v44, 0.5, v44
    v_mul_f32 v40, v40, v44

    v_mul_f32 v44, v41, v41
    v_mul_f32 v44, v44, v41
    v_fma_f32 v44, v44, s27, v41
    v_mul_f32 v44, s26, v44
    v_mul_f32 v44, s51, v44
    v_exp_f32 v44, v44
    s_nop 0
    v_add_f32 v44, 1.0, v44
    v_rcp_f32 v44, v44
    s_nop 0
    v_fma_f32 v44, v44, -2.0, 1.0
    v_add_f32 v44, 1.0, v44
    v_mul_f32 v44, 0.5, v44
    v_mul_f32 v41, v41, v44

    v_mul_f32 v44, v42, v42
    v_mul_f32 v44, v44, v42
    v_fma_f32 v44, v44, s27, v42
    v_mul_f32 v44, s26, v44
    v_mul_f32 v44, s51, v44
    v_exp_f32 v44, v44
    s_nop 0
    v_add_f32 v44, 1.0, v44
    v_rcp_f32 v44, v44
    s_nop 0
    v_fma_f32 v44, v44, -2.0, 1.0
    v_add_f32 v44, 1.0, v44
    v_mul_f32 v44, 0.5, v44
    v_mul_f32 v42, v42, v44

    v_mul_f32 v44, v43, v43
    v_mul_f32 v44, v44, v43
    v_fma_f32 v44, v44, s27, v43
    v_mul_f32 v44, s26, v44
    v_mul_f32 v44, s51, v44
    v_exp_f32 v44, v44
    s_nop 0
    v_add_f32 v44, 1.0, v44
    v_rcp_f32 v44, v44
    s_nop 0
    v_fma_f32 v44, v44, -2.0, 1.0
    v_add_f32 v44, 1.0, v44
    v_mul_f32 v44, 0.5, v44
    v_mul_f32 v43, v43, v44

    v_cvt_pk_bf16_f32 v22, v40, v41
    v_cvt_pk_bf16_f32 v23, v42, v43

    buffer_store_dwordx2 v[16:17], v1, s[28:31], 0 offen offset:0
    buffer_store_dwordx2 v[18:19], v1, s[28:31], 0 offen offset:32
    buffer_store_dwordx2 v[20:21], v1, s[28:31], 0 offen offset:64
    buffer_store_dwordx2 v[22:23], v1, s[28:31], 0 offen offset:96
    v_add_u32 v1, s25, v1
    s_nop 1
    v_cvt_pk_bf16_f32 v9, v76, v77
    v_cvt_pk_bf16_f32 v10, v78, v79
    v_lshlrev_b32 v40, 16, v9
    v_and_b32 v41, 0xffff0000, v9
    v_lshlrev_b32 v42, 16, v10
    v_and_b32 v43, 0xffff0000, v10
    v_add_f32 v40, v40, v24
    v_add_f32 v41, v41, v25
    v_add_f32 v42, v42, v26
    v_add_f32 v43, v43, v27
    v_cvt_pk_bf16_f32 v9, v40, v41
    v_cvt_pk_bf16_f32 v10, v42, v43
    v_lshlrev_b32 v40, 16, v9
    v_and_b32 v41, 0xffff0000, v9
    v_lshlrev_b32 v42, 16, v10
    v_and_b32 v43, 0xffff0000, v10

    v_mul_f32 v44, v40, v40
    v_mul_f32 v44, v44, v40
    v_fma_f32 v44, v44, s27, v40
    v_mul_f32 v44, s26, v44
    v_mul_f32 v44, s51, v44
    v_exp_f32 v44, v44
    s_nop 0
    v_add_f32 v44, 1.0, v44
    v_rcp_f32 v44, v44
    s_nop 0
    v_fma_f32 v44, v44, -2.0, 1.0
    v_add_f32 v44, 1.0, v44
    v_mul_f32 v44, 0.5, v44
    v_mul_f32 v40, v40, v44

    v_mul_f32 v44, v41, v41
    v_mul_f32 v44, v44, v41
    v_fma_f32 v44, v44, s27, v41
    v_mul_f32 v44, s26, v44
    v_mul_f32 v44, s51, v44
    v_exp_f32 v44, v44
    s_nop 0
    v_add_f32 v44, 1.0, v44
    v_rcp_f32 v44, v44
    s_nop 0
    v_fma_f32 v44, v44, -2.0, 1.0
    v_add_f32 v44, 1.0, v44
    v_mul_f32 v44, 0.5, v44
    v_mul_f32 v41, v41, v44

    v_mul_f32 v44, v42, v42
    v_mul_f32 v44, v44, v42
    v_fma_f32 v44, v44, s27, v42
    v_mul_f32 v44, s26, v44
    v_mul_f32 v44, s51, v44
    v_exp_f32 v44, v44
    s_nop 0
    v_add_f32 v44, 1.0, v44
    v_rcp_f32 v44, v44
    s_nop 0
    v_fma_f32 v44, v44, -2.0, 1.0
    v_add_f32 v44, 1.0, v44
    v_mul_f32 v44, 0.5, v44
    v_mul_f32 v42, v42, v44

    v_mul_f32 v44, v43, v43
    v_mul_f32 v44, v44, v43
    v_fma_f32 v44, v44, s27, v43
    v_mul_f32 v44, s26, v44
    v_mul_f32 v44, s51, v44
    v_exp_f32 v44, v44
    s_nop 0
    v_add_f32 v44, 1.0, v44
    v_rcp_f32 v44, v44
    s_nop 0
    v_fma_f32 v44, v44, -2.0, 1.0
    v_add_f32 v44, 1.0, v44
    v_mul_f32 v44, 0.5, v44
    v_mul_f32 v43, v43, v44

    v_cvt_pk_bf16_f32 v16, v40, v41
    v_cvt_pk_bf16_f32 v17, v42, v43

    v_cvt_pk_bf16_f32 v9, v92, v93
    v_cvt_pk_bf16_f32 v10, v94, v95
    v_lshlrev_b32 v40, 16, v9
    v_and_b32 v41, 0xffff0000, v9
    v_lshlrev_b32 v42, 16, v10
    v_and_b32 v43, 0xffff0000, v10
    v_add_f32 v40, v40, v28
    v_add_f32 v41, v41, v29
    v_add_f32 v42, v42, v30
    v_add_f32 v43, v43, v31
    v_cvt_pk_bf16_f32 v9, v40, v41
    v_cvt_pk_bf16_f32 v10, v42, v43
    v_lshlrev_b32 v40, 16, v9
    v_and_b32 v41, 0xffff0000, v9
    v_lshlrev_b32 v42, 16, v10
    v_and_b32 v43, 0xffff0000, v10

    v_mul_f32 v44, v40, v40
    v_mul_f32 v44, v44, v40
    v_fma_f32 v44, v44, s27, v40
    v_mul_f32 v44, s26, v44
    v_mul_f32 v44, s51, v44
    v_exp_f32 v44, v44
    s_nop 0
    v_add_f32 v44, 1.0, v44
    v_rcp_f32 v44, v44
    s_nop 0
    v_fma_f32 v44, v44, -2.0, 1.0
    v_add_f32 v44, 1.0, v44
    v_mul_f32 v44, 0.5, v44
    v_mul_f32 v40, v40, v44

    v_mul_f32 v44, v41, v41
    v_mul_f32 v44, v44, v41
    v_fma_f32 v44, v44, s27, v41
    v_mul_f32 v44, s26, v44
    v_mul_f32 v44, s51, v44
    v_exp_f32 v44, v44
    s_nop 0
    v_add_f32 v44, 1.0, v44
    v_rcp_f32 v44, v44
    s_nop 0
    v_fma_f32 v44, v44, -2.0, 1.0
    v_add_f32 v44, 1.0, v44
    v_mul_f32 v44, 0.5, v44
    v_mul_f32 v41, v41, v44

    v_mul_f32 v44, v42, v42
    v_mul_f32 v44, v44, v42
    v_fma_f32 v44, v44, s27, v42
    v_mul_f32 v44, s26, v44
    v_mul_f32 v44, s51, v44
    v_exp_f32 v44, v44
    s_nop 0
    v_add_f32 v44, 1.0, v44
    v_rcp_f32 v44, v44
    s_nop 0
    v_fma_f32 v44, v44, -2.0, 1.0
    v_add_f32 v44, 1.0, v44
    v_mul_f32 v44, 0.5, v44
    v_mul_f32 v42, v42, v44

    v_mul_f32 v44, v43, v43
    v_mul_f32 v44, v44, v43
    v_fma_f32 v44, v44, s27, v43
    v_mul_f32 v44, s26, v44
    v_mul_f32 v44, s51, v44
    v_exp_f32 v44, v44
    s_nop 0
    v_add_f32 v44, 1.0, v44
    v_rcp_f32 v44, v44
    s_nop 0
    v_fma_f32 v44, v44, -2.0, 1.0
    v_add_f32 v44, 1.0, v44
    v_mul_f32 v44, 0.5, v44
    v_mul_f32 v43, v43, v44

    v_cvt_pk_bf16_f32 v18, v40, v41
    v_cvt_pk_bf16_f32 v19, v42, v43

    v_cvt_pk_bf16_f32 v9, v108, v109
    v_cvt_pk_bf16_f32 v10, v110, v111
    v_lshlrev_b32 v40, 16, v9
    v_and_b32 v41, 0xffff0000, v9
    v_lshlrev_b32 v42, 16, v10
    v_and_b32 v43, 0xffff0000, v10
    v_add_f32 v40, v40, v32
    v_add_f32 v41, v41, v33
    v_add_f32 v42, v42, v34
    v_add_f32 v43, v43, v35
    v_cvt_pk_bf16_f32 v9, v40, v41
    v_cvt_pk_bf16_f32 v10, v42, v43
    v_lshlrev_b32 v40, 16, v9
    v_and_b32 v41, 0xffff0000, v9
    v_lshlrev_b32 v42, 16, v10
    v_and_b32 v43, 0xffff0000, v10

    v_mul_f32 v44, v40, v40
    v_mul_f32 v44, v44, v40
    v_fma_f32 v44, v44, s27, v40
    v_mul_f32 v44, s26, v44
    v_mul_f32 v44, s51, v44
    v_exp_f32 v44, v44
    s_nop 0
    v_add_f32 v44, 1.0, v44
    v_rcp_f32 v44, v44
    s_nop 0
    v_fma_f32 v44, v44, -2.0, 1.0
    v_add_f32 v44, 1.0, v44
    v_mul_f32 v44, 0.5, v44
    v_mul_f32 v40, v40, v44

    v_mul_f32 v44, v41, v41
    v_mul_f32 v44, v44, v41
    v_fma_f32 v44, v44, s27, v41
    v_mul_f32 v44, s26, v44
    v_mul_f32 v44, s51, v44
    v_exp_f32 v44, v44
    s_nop 0
    v_add_f32 v44, 1.0, v44
    v_rcp_f32 v44, v44
    s_nop 0
    v_fma_f32 v44, v44, -2.0, 1.0
    v_add_f32 v44, 1.0, v44
    v_mul_f32 v44, 0.5, v44
    v_mul_f32 v41, v41, v44

    v_mul_f32 v44, v42, v42
    v_mul_f32 v44, v44, v42
    v_fma_f32 v44, v44, s27, v42
    v_mul_f32 v44, s26, v44
    v_mul_f32 v44, s51, v44
    v_exp_f32 v44, v44
    s_nop 0
    v_add_f32 v44, 1.0, v44
    v_rcp_f32 v44, v44
    s_nop 0
    v_fma_f32 v44, v44, -2.0, 1.0
    v_add_f32 v44, 1.0, v44
    v_mul_f32 v44, 0.5, v44
    v_mul_f32 v42, v42, v44

    v_mul_f32 v44, v43, v43
    v_mul_f32 v44, v44, v43
    v_fma_f32 v44, v44, s27, v43
    v_mul_f32 v44, s26, v44
    v_mul_f32 v44, s51, v44
    v_exp_f32 v44, v44
    s_nop 0
    v_add_f32 v44, 1.0, v44
    v_rcp_f32 v44, v44
    s_nop 0
    v_fma_f32 v44, v44, -2.0, 1.0
    v_add_f32 v44, 1.0, v44
    v_mul_f32 v44, 0.5, v44
    v_mul_f32 v43, v43, v44

    v_cvt_pk_bf16_f32 v20, v40, v41
    v_cvt_pk_bf16_f32 v21, v42, v43

    v_cvt_pk_bf16_f32 v9, v124, v125
    v_cvt_pk_bf16_f32 v10, v126, v127
    v_lshlrev_b32 v40, 16, v9
    v_and_b32 v41, 0xffff0000, v9
    v_lshlrev_b32 v42, 16, v10
    v_and_b32 v43, 0xffff0000, v10
    v_add_f32 v40, v40, v36
    v_add_f32 v41, v41, v37
    v_add_f32 v42, v42, v38
    v_add_f32 v43, v43, v39
    v_cvt_pk_bf16_f32 v9, v40, v41
    v_cvt_pk_bf16_f32 v10, v42, v43
    v_lshlrev_b32 v40, 16, v9
    v_and_b32 v41, 0xffff0000, v9
    v_lshlrev_b32 v42, 16, v10
    v_and_b32 v43, 0xffff0000, v10

    v_mul_f32 v44, v40, v40
    v_mul_f32 v44, v44, v40
    v_fma_f32 v44, v44, s27, v40
    v_mul_f32 v44, s26, v44
    v_mul_f32 v44, s51, v44
    v_exp_f32 v44, v44
    s_nop 0
    v_add_f32 v44, 1.0, v44
    v_rcp_f32 v44, v44
    s_nop 0
    v_fma_f32 v44, v44, -2.0, 1.0
    v_add_f32 v44, 1.0, v44
    v_mul_f32 v44, 0.5, v44
    v_mul_f32 v40, v40, v44

    v_mul_f32 v44, v41, v41
    v_mul_f32 v44, v44, v41
    v_fma_f32 v44, v44, s27, v41
    v_mul_f32 v44, s26, v44
    v_mul_f32 v44, s51, v44
    v_exp_f32 v44, v44
    s_nop 0
    v_add_f32 v44, 1.0, v44
    v_rcp_f32 v44, v44
    s_nop 0
    v_fma_f32 v44, v44, -2.0, 1.0
    v_add_f32 v44, 1.0, v44
    v_mul_f32 v44, 0.5, v44
    v_mul_f32 v41, v41, v44

    v_mul_f32 v44, v42, v42
    v_mul_f32 v44, v44, v42
    v_fma_f32 v44, v44, s27, v42
    v_mul_f32 v44, s26, v44
    v_mul_f32 v44, s51, v44
    v_exp_f32 v44, v44
    s_nop 0
    v_add_f32 v44, 1.0, v44
    v_rcp_f32 v44, v44
    s_nop 0
    v_fma_f32 v44, v44, -2.0, 1.0
    v_add_f32 v44, 1.0, v44
    v_mul_f32 v44, 0.5, v44
    v_mul_f32 v42, v42, v44

    v_mul_f32 v44, v43, v43
    v_mul_f32 v44, v44, v43
    v_fma_f32 v44, v44, s27, v43
    v_mul_f32 v44, s26, v44
    v_mul_f32 v44, s51, v44
    v_exp_f32 v44, v44
    s_nop 0
    v_add_f32 v44, 1.0, v44
    v_rcp_f32 v44, v44
    s_nop 0
    v_fma_f32 v44, v44, -2.0, 1.0
    v_add_f32 v44, 1.0, v44
    v_mul_f32 v44, 0.5, v44
    v_mul_f32 v43, v43, v44

    v_cvt_pk_bf16_f32 v22, v40, v41
    v_cvt_pk_bf16_f32 v23, v42, v43

    buffer_store_dwordx2 v[16:17], v1, s[28:31], 0 offen offset:0
    buffer_store_dwordx2 v[18:19], v1, s[28:31], 0 offen offset:32
    buffer_store_dwordx2 v[20:21], v1, s[28:31], 0 offen offset:64
    buffer_store_dwordx2 v[22:23], v1, s[28:31], 0 offen offset:96
    v_add_u32 v1, s25, v1
    s_nop 1
K2_END:
    s_endpgm
.globl k3_rec_kernel
.p2align 8
.type k3_rec_kernel,@function
k3_rec_kernel:
    s_cmp_ge_u32 s2, 256
    s_cbranch_scc1 K3_END
    s_load_dwordx2 s[4:5], s[0:1], 16
    s_load_dwordx2 s[6:7], s[0:1], 24
    s_load_dwordx2 s[8:9], s[0:1], 32
    s_load_dwordx2 s[10:11], s[0:1], 40
    s_load_dwordx2 s[12:13], s[0:1], 112
    s_load_dwordx2 s[14:15], s[0:1], 8
    s_and_b32 s16, s2, 31
    s_lshr_b32 s17, s2, 5
    v_lshrrev_b32 v1, 6, v0
    v_and_b32 v2, 63, v0
    v_and_b32 v3, 15, v2
    v_lshrrev_b32 v4, 4, v2
    s_waitcnt lgkmcnt(0)
    v_readfirstlane_b32 s18, v1

    s_mov_b32 s28, s12
    s_and_b32 s29, s13, 0xffff
    s_mov_b32 s30, 268435456
    s_mov_b32 s31, 0x00020000

    s_mov_b32 s32, s4
    s_and_b32 s33, s5, 0xffff
    s_mov_b32 s34, 8388608
    s_mov_b32 s35, 0x00020000

    s_mov_b32 s36, s6
    s_and_b32 s37, s7, 0xffff
    s_mov_b32 s38, 8388608
    s_mov_b32 s39, 0x00020000

    s_mov_b32 s40, s8
    s_and_b32 s41, s9, 0xffff
    s_mov_b32 s42, 8388608
    s_mov_b32 s43, 0x00020000

    s_mov_b32 s44, s10
    s_and_b32 s45, s11, 0xffff
    s_mov_b32 s46, 8388608
    s_mov_b32 s47, 0x00020000

    s_mov_b32 s48, s14
    s_and_b32 s49, s15, 0xffff
    s_mov_b32 s50, 16384
    s_mov_b32 s51, 0x00020000

    s_lshl_b32 s19, s18, 8
    s_lshl_b32 s20, s16, 8
    s_lshl_b32 s21, s17, 5
    s_add_u32 s20, s20, s21
    s_mul_i32 s22, s18, 24576
    s_add_u32 s22, s22, 65536
    v_add_u32 v5, s19, v2
    v_lshlrev_b32 v5, 13, v5
    v_add_u32 v5, s20, v5
    v_mul_u32_u24 v6, 96, v2
    v_add_u32 v6, s22, v6

    buffer_load_dwordx4 v[16:19], v5, s[32:35], 0 offen
    buffer_load_dwordx4 v[20:23], v5, s[32:35], 0 offen offset:16
    s_waitcnt vmcnt(0)
    ds_write_b128 v6, v[16:19] offset:0
    ds_write_b128 v6, v[20:23] offset:16

    buffer_load_dwordx4 v[16:19], v5, s[36:39], 0 offen
    buffer_load_dwordx4 v[20:23], v5, s[36:39], 0 offen offset:16
    s_waitcnt vmcnt(0)
    ds_write_b128 v6, v[16:19] offset:32
    ds_write_b128 v6, v[20:23] offset:48

    buffer_load_dwordx4 v[16:19], v5, s[40:43], 0 offen
    buffer_load_dwordx4 v[20:23], v5, s[40:43], 0 offen offset:16
    s_waitcnt vmcnt(0)
    ds_write_b128 v6, v[16:19] offset:64
    ds_write_b128 v6, v[20:23] offset:80

    v_add_u32 v5, 524288, v5
    v_add_u32 v6, 6144, v6

    buffer_load_dwordx4 v[16:19], v5, s[32:35], 0 offen
    buffer_load_dwordx4 v[20:23], v5, s[32:35], 0 offen offset:16
    s_waitcnt vmcnt(0)
    ds_write_b128 v6, v[16:19] offset:0
    ds_write_b128 v6, v[20:23] offset:16

    buffer_load_dwordx4 v[16:19], v5, s[36:39], 0 offen
    buffer_load_dwordx4 v[20:23], v5, s[36:39], 0 offen offset:16
    s_waitcnt vmcnt(0)
    ds_write_b128 v6, v[16:19] offset:32
    ds_write_b128 v6, v[20:23] offset:48

    buffer_load_dwordx4 v[16:19], v5, s[40:43], 0 offen
    buffer_load_dwordx4 v[20:23], v5, s[40:43], 0 offen offset:16
    s_waitcnt vmcnt(0)
    ds_write_b128 v6, v[16:19] offset:64
    ds_write_b128 v6, v[20:23] offset:80

    v_add_u32 v5, 524288, v5
    v_add_u32 v6, 6144, v6

    buffer_load_dwordx4 v[16:19], v5, s[32:35], 0 offen
    buffer_load_dwordx4 v[20:23], v5, s[32:35], 0 offen offset:16
    s_waitcnt vmcnt(0)
    ds_write_b128 v6, v[16:19] offset:0
    ds_write_b128 v6, v[20:23] offset:16

    buffer_load_dwordx4 v[16:19], v5, s[36:39], 0 offen
    buffer_load_dwordx4 v[20:23], v5, s[36:39], 0 offen offset:16
    s_waitcnt vmcnt(0)
    ds_write_b128 v6, v[16:19] offset:32
    ds_write_b128 v6, v[20:23] offset:48

    buffer_load_dwordx4 v[16:19], v5, s[40:43], 0 offen
    buffer_load_dwordx4 v[20:23], v5, s[40:43], 0 offen offset:16
    s_waitcnt vmcnt(0)
    ds_write_b128 v6, v[16:19] offset:64
    ds_write_b128 v6, v[20:23] offset:80

    v_add_u32 v5, 524288, v5
    v_add_u32 v6, 6144, v6

    buffer_load_dwordx4 v[16:19], v5, s[32:35], 0 offen
    buffer_load_dwordx4 v[20:23], v5, s[32:35], 0 offen offset:16
    s_waitcnt vmcnt(0)
    ds_write_b128 v6, v[16:19] offset:0
    ds_write_b128 v6, v[20:23] offset:16

    buffer_load_dwordx4 v[16:19], v5, s[36:39], 0 offen
    buffer_load_dwordx4 v[20:23], v5, s[36:39], 0 offen offset:16
    s_waitcnt vmcnt(0)
    ds_write_b128 v6, v[16:19] offset:32
    ds_write_b128 v6, v[20:23] offset:48

    buffer_load_dwordx4 v[16:19], v5, s[40:43], 0 offen
    buffer_load_dwordx4 v[20:23], v5, s[40:43], 0 offen offset:16
    s_waitcnt vmcnt(0)
    ds_write_b128 v6, v[16:19] offset:64
    ds_write_b128 v6, v[20:23] offset:80

    v_add_u32 v5, 524288, v5
    v_add_u32 v6, 6144, v6

    s_waitcnt lgkmcnt(0)
    v_bfe_u32 v5, v2, 2, 2
    v_lshl_add_u32 v5, v4, 3, v5
    v_mul_u32_u24 v5, 96, v5
    v_and_b32 v6, 3, v2
    v_lshl_add_u32 v5, v6, 3, v5
    v_add_u32 v5, s22, v5

    ds_read_b64_tr_b16 v[16:17], v5 offset:0
    ds_read_b64_tr_b16 v[18:19], v5 offset:384
    s_waitcnt lgkmcnt(0)
    v_accvgpr_write_b32 a0, v16
    v_accvgpr_write_b32 a1, v17
    v_accvgpr_write_b32 a2, v18
    v_accvgpr_write_b32 a3, v19

    ds_read_b64_tr_b16 v[16:17], v5 offset:32
    ds_read_b64_tr_b16 v[18:19], v5 offset:416
    s_waitcnt lgkmcnt(0)
    v_accvgpr_write_b32 a4, v16
    v_accvgpr_write_b32 a5, v17
    v_accvgpr_write_b32 a6, v18
    v_accvgpr_write_b32 a7, v19

    ds_read_b64_tr_b16 v[16:17], v5 offset:64
    ds_read_b64_tr_b16 v[18:19], v5 offset:448
    s_waitcnt lgkmcnt(0)
    v_accvgpr_write_b32 a8, v16
    v_accvgpr_write_b32 a9, v17
    v_accvgpr_write_b32 a10, v18
    v_accvgpr_write_b32 a11, v19

    ds_read_b64_tr_b16 v[16:17], v5 offset:3072
    ds_read_b64_tr_b16 v[18:19], v5 offset:3456
    s_waitcnt lgkmcnt(0)
    v_accvgpr_write_b32 a12, v16
    v_accvgpr_write_b32 a13, v17
    v_accvgpr_write_b32 a14, v18
    v_accvgpr_write_b32 a15, v19

    ds_read_b64_tr_b16 v[16:17], v5 offset:3104
    ds_read_b64_tr_b16 v[18:19], v5 offset:3488
    s_waitcnt lgkmcnt(0)
    v_accvgpr_write_b32 a16, v16
    v_accvgpr_write_b32 a17, v17
    v_accvgpr_write_b32 a18, v18
    v_accvgpr_write_b32 a19, v19

    ds_read_b64_tr_b16 v[16:17], v5 offset:3136
    ds_read_b64_tr_b16 v[18:19], v5 offset:3520
    s_waitcnt lgkmcnt(0)
    v_accvgpr_write_b32 a20, v16
    v_accvgpr_write_b32 a21, v17
    v_accvgpr_write_b32 a22, v18
    v_accvgpr_write_b32 a23, v19

    ds_read_b64_tr_b16 v[16:17], v5 offset:6144
    ds_read_b64_tr_b16 v[18:19], v5 offset:6528
    s_waitcnt lgkmcnt(0)
    v_accvgpr_write_b32 a24, v16
    v_accvgpr_write_b32 a25, v17
    v_accvgpr_write_b32 a26, v18
    v_accvgpr_write_b32 a27, v19

    ds_read_b64_tr_b16 v[16:17], v5 offset:6176
    ds_read_b64_tr_b16 v[18:19], v5 offset:6560
    s_waitcnt lgkmcnt(0)
    v_accvgpr_write_b32 a28, v16
    v_accvgpr_write_b32 a29, v17
    v_accvgpr_write_b32 a30, v18
    v_accvgpr_write_b32 a31, v19

    ds_read_b64_tr_b16 v[16:17], v5 offset:6208
    ds_read_b64_tr_b16 v[18:19], v5 offset:6592
    s_waitcnt lgkmcnt(0)
    v_accvgpr_write_b32 a32, v16
    v_accvgpr_write_b32 a33, v17
    v_accvgpr_write_b32 a34, v18
    v_accvgpr_write_b32 a35, v19

    ds_read_b64_tr_b16 v[16:17], v5 offset:9216
    ds_read_b64_tr_b16 v[18:19], v5 offset:9600
    s_waitcnt lgkmcnt(0)
    v_accvgpr_write_b32 a36, v16
    v_accvgpr_write_b32 a37, v17
    v_accvgpr_write_b32 a38, v18
    v_accvgpr_write_b32 a39, v19

    ds_read_b64_tr_b16 v[16:17], v5 offset:9248
    ds_read_b64_tr_b16 v[18:19], v5 offset:9632
    s_waitcnt lgkmcnt(0)
    v_accvgpr_write_b32 a40, v16
    v_accvgpr_write_b32 a41, v17
    v_accvgpr_write_b32 a42, v18
    v_accvgpr_write_b32 a43, v19

    ds_read_b64_tr_b16 v[16:17], v5 offset:9280
    ds_read_b64_tr_b16 v[18:19], v5 offset:9664
    s_waitcnt lgkmcnt(0)
    v_accvgpr_write_b32 a44, v16
    v_accvgpr_write_b32 a45, v17
    v_accvgpr_write_b32 a46, v18
    v_accvgpr_write_b32 a47, v19

    ds_read_b64_tr_b16 v[16:17], v5 offset:12288
    ds_read_b64_tr_b16 v[18:19], v5 offset:12672
    s_waitcnt lgkmcnt(0)
    v_accvgpr_write_b32 a48, v16
    v_accvgpr_write_b32 a49, v17
    v_accvgpr_write_b32 a50, v18
    v_accvgpr_write_b32 a51, v19

    ds_read_b64_tr_b16 v[16:17], v5 offset:12320
    ds_read_b64_tr_b16 v[18:19], v5 offset:12704
    s_waitcnt lgkmcnt(0)
    v_accvgpr_write_b32 a52, v16
    v_accvgpr_write_b32 a53, v17
    v_accvgpr_write_b32 a54, v18
    v_accvgpr_write_b32 a55, v19

    ds_read_b64_tr_b16 v[16:17], v5 offset:12352
    ds_read_b64_tr_b16 v[18:19], v5 offset:12736
    s_waitcnt lgkmcnt(0)
    v_accvgpr_write_b32 a56, v16
    v_accvgpr_write_b32 a57, v17
    v_accvgpr_write_b32 a58, v18
    v_accvgpr_write_b32 a59, v19

    ds_read_b64_tr_b16 v[16:17], v5 offset:15360
    ds_read_b64_tr_b16 v[18:19], v5 offset:15744
    s_waitcnt lgkmcnt(0)
    v_accvgpr_write_b32 a60, v16
    v_accvgpr_write_b32 a61, v17
    v_accvgpr_write_b32 a62, v18
    v_accvgpr_write_b32 a63, v19

    ds_read_b64_tr_b16 v[16:17], v5 offset:15392
    ds_read_b64_tr_b16 v[18:19], v5 offset:15776
    s_waitcnt lgkmcnt(0)
    v_accvgpr_write_b32 a64, v16
    v_accvgpr_write_b32 a65, v17
    v_accvgpr_write_b32 a66, v18
    v_accvgpr_write_b32 a67, v19

    ds_read_b64_tr_b16 v[16:17], v5 offset:15424
    ds_read_b64_tr_b16 v[18:19], v5 offset:15808
    s_waitcnt lgkmcnt(0)
    v_accvgpr_write_b32 a68, v16
    v_accvgpr_write_b32 a69, v17
    v_accvgpr_write_b32 a70, v18
    v_accvgpr_write_b32 a71, v19

    ds_read_b64_tr_b16 v[16:17], v5 offset:18432
    ds_read_b64_tr_b16 v[18:19], v5 offset:18816
    s_waitcnt lgkmcnt(0)
    v_accvgpr_write_b32 a72, v16
    v_accvgpr_write_b32 a73, v17
    v_accvgpr_write_b32 a74, v18
    v_accvgpr_write_b32 a75, v19

    ds_read_b64_tr_b16 v[16:17], v5 offset:18464
    ds_read_b64_tr_b16 v[18:19], v5 offset:18848
    s_waitcnt lgkmcnt(0)
    v_accvgpr_write_b32 a76, v16
    v_accvgpr_write_b32 a77, v17
    v_accvgpr_write_b32 a78, v18
    v_accvgpr_write_b32 a79, v19

    ds_read_b64_tr_b16 v[16:17], v5 offset:18496
    ds_read_b64_tr_b16 v[18:19], v5 offset:18880
    s_waitcnt lgkmcnt(0)
    v_accvgpr_write_b32 a80, v16
    v_accvgpr_write_b32 a81, v17
    v_accvgpr_write_b32 a82, v18
    v_accvgpr_write_b32 a83, v19

    ds_read_b64_tr_b16 v[16:17], v5 offset:21504
    ds_read_b64_tr_b16 v[18:19], v5 offset:21888
    s_waitcnt lgkmcnt(0)
    v_accvgpr_write_b32 a84, v16
    v_accvgpr_write_b32 a85, v17
    v_accvgpr_write_b32 a86, v18
    v_accvgpr_write_b32 a87, v19

    ds_read_b64_tr_b16 v[16:17], v5 offset:21536
    ds_read_b64_tr_b16 v[18:19], v5 offset:21920
    s_waitcnt lgkmcnt(0)
    v_accvgpr_write_b32 a88, v16
    v_accvgpr_write_b32 a89, v17
    v_accvgpr_write_b32 a90, v18
    v_accvgpr_write_b32 a91, v19

    ds_read_b64_tr_b16 v[16:17], v5 offset:21568
    ds_read_b64_tr_b16 v[18:19], v5 offset:21952
    s_waitcnt lgkmcnt(0)
    v_accvgpr_write_b32 a92, v16
    v_accvgpr_write_b32 a93, v17
    v_accvgpr_write_b32 a94, v18
    v_accvgpr_write_b32 a95, v19

    v_lshrrev_b32 v5, 4, v0
    v_and_b32 v6, 15, v0
    s_lshl_b32 s19, s16, 7
    v_add_u32 v7, s19, v5
    v_lshlrev_b32 v7, 11, v7
    v_lshl_add_u32 v7, v6, 4, v7
    s_lshl_b32 s21, s17, 8
    v_add_u32 v7, s21, v7
    v_mul_u32_u24 v8, 272, v5
    v_lshl_add_u32 v8, v6, 4, v8
    v_add_u32 v8, 16384, v8

    buffer_load_dwordx4 v[16:19], v7, s[44:47], 0 offen
    s_waitcnt vmcnt(0)
    ds_write_b128 v8, v[16:19]
    v_add_u32 v7, 32768, v7
    v_add_u32 v8, 4352, v8

    buffer_load_dwordx4 v[16:19], v7, s[44:47], 0 offen
    s_waitcnt vmcnt(0)
    ds_write_b128 v8, v[16:19]
    v_add_u32 v7, 32768, v7
    v_add_u32 v8, 4352, v8

    buffer_load_dwordx4 v[16:19], v7, s[44:47], 0 offen
    s_waitcnt vmcnt(0)
    ds_write_b128 v8, v[16:19]
    v_add_u32 v7, 32768, v7
    v_add_u32 v8, 4352, v8

    buffer_load_dwordx4 v[16:19], v7, s[44:47], 0 offen
    s_waitcnt vmcnt(0)
    ds_write_b128 v8, v[16:19]
    v_add_u32 v7, 32768, v7
    v_add_u32 v8, 4352, v8

    buffer_load_dwordx4 v[16:19], v7, s[44:47], 0 offen
    s_waitcnt vmcnt(0)
    ds_write_b128 v8, v[16:19]
    v_add_u32 v7, 32768, v7
    v_add_u32 v8, 4352, v8

    buffer_load_dwordx4 v[16:19], v7, s[44:47], 0 offen
    s_waitcnt vmcnt(0)
    ds_write_b128 v8, v[16:19]
    v_add_u32 v7, 32768, v7
    v_add_u32 v8, 4352, v8

    buffer_load_dwordx4 v[16:19], v7, s[44:47], 0 offen
    s_waitcnt vmcnt(0)
    ds_write_b128 v8, v[16:19]
    v_add_u32 v7, 32768, v7
    v_add_u32 v8, 4352, v8

    buffer_load_dwordx4 v[16:19], v7, s[44:47], 0 offen
    s_waitcnt vmcnt(0)
    ds_write_b128 v8, v[16:19]
    v_add_u32 v7, 32768, v7
    v_add_u32 v8, 4352, v8

    s_waitcnt lgkmcnt(0)
    s_barrier
    v_bfe_u32 v5, v2, 2, 2
    v_lshl_add_u32 v5, v4, 2, v5
    v_mul_u32_u24 v5, 272, v5
    v_and_b32 v6, 3, v2
    v_lshl_add_u32 v5, v6, 3, v5
    s_lshl_b32 s19, s18, 6
    v_add_u32 v5, s19, v5
    v_add_u32 v5, 16384, v5

    ds_read_b64_tr_b16 v[16:17], v5 offset:0
    ds_read_b64_tr_b16 v[18:19], v5 offset:4352
    s_waitcnt lgkmcnt(0)
    v_accvgpr_write_b32 a96, v16
    v_accvgpr_write_b32 a97, v17
    v_accvgpr_write_b32 a98, v18
    v_accvgpr_write_b32 a99, v19

    ds_read_b64_tr_b16 v[16:17], v5 offset:8704
    ds_read_b64_tr_b16 v[18:19], v5 offset:13056
    s_waitcnt lgkmcnt(0)
    v_accvgpr_write_b32 a100, v16
    v_accvgpr_write_b32 a101, v17
    v_accvgpr_write_b32 a102, v18
    v_accvgpr_write_b32 a103, v19

    ds_read_b64_tr_b16 v[16:17], v5 offset:17408
    ds_read_b64_tr_b16 v[18:19], v5 offset:21760
    s_waitcnt lgkmcnt(0)
    v_accvgpr_write_b32 a104, v16
    v_accvgpr_write_b32 a105, v17
    v_accvgpr_write_b32 a106, v18
    v_accvgpr_write_b32 a107, v19

    ds_read_b64_tr_b16 v[16:17], v5 offset:26112
    ds_read_b64_tr_b16 v[18:19], v5 offset:30464
    s_waitcnt lgkmcnt(0)
    v_accvgpr_write_b32 a108, v16
    v_accvgpr_write_b32 a109, v17
    v_accvgpr_write_b32 a110, v18
    v_accvgpr_write_b32 a111, v19

    ds_read_b64_tr_b16 v[16:17], v5 offset:32
    ds_read_b64_tr_b16 v[18:19], v5 offset:4384
    s_waitcnt lgkmcnt(0)
    v_accvgpr_write_b32 a112, v16
    v_accvgpr_write_b32 a113, v17
    v_accvgpr_write_b32 a114, v18
    v_accvgpr_write_b32 a115, v19

    ds_read_b64_tr_b16 v[16:17], v5 offset:8736
    ds_read_b64_tr_b16 v[18:19], v5 offset:13088
    s_waitcnt lgkmcnt(0)
    v_accvgpr_write_b32 a116, v16
    v_accvgpr_write_b32 a117, v17
    v_accvgpr_write_b32 a118, v18
    v_accvgpr_write_b32 a119, v19

    ds_read_b64_tr_b16 v[16:17], v5 offset:17440
    ds_read_b64_tr_b16 v[18:19], v5 offset:21792
    s_waitcnt lgkmcnt(0)
    v_accvgpr_write_b32 a120, v16
    v_accvgpr_write_b32 a121, v17
    v_accvgpr_write_b32 a122, v18
    v_accvgpr_write_b32 a123, v19

    ds_read_b64_tr_b16 v[16:17], v5 offset:26144
    ds_read_b64_tr_b16 v[18:19], v5 offset:30496
    s_waitcnt lgkmcnt(0)
    v_accvgpr_write_b32 a124, v16
    v_accvgpr_write_b32 a125, v17
    v_accvgpr_write_b32 a126, v18
    v_accvgpr_write_b32 a127, v19

    s_barrier
    s_mov_b32 s60, 0

    v_and_b32 v8, 7, v2
    v_lshlrev_b32 v5, 11, v8
    s_lshl_b32 s19, s18, 9
    v_lshl_add_u32 v5, v4, 4, v5
    v_add_u32 v5, s19, v5
    s_lshl_b32 s20, s16, 8
    v_lshl_add_u32 v6, v4, 4, s20
    s_mul_i32 s21, s18, 13056
    s_add_u32 s21, s21, 16384
    v_bfe_u32 v7, v2, 2, 2
    v_lshl_add_u32 v7, v4, 2, v7
    v_mul_u32_u24 v7, 272, v7
    v_and_b32 v9, 3, v2
    v_lshl_add_u32 v7, v9, 3, v7
    v_add_u32 v7, s21, v7

K3_STEP:
    s_mov_b32 s62, s60
    s_lshl_b32 s63, s62, 5

    v_add_u32 v224, 8, v3
    v_min_u32 v224, 31, v224
    v_add_u32 v224, s63, v224
    v_lshlrev_b32 v224, 13, v224
    v_add_u32 v224, v224, v6
    v_add_u32 v224, 20971520, v224

    buffer_load_dwordx4 v[92:95], v224, s[28:31], 0 offen offset:0
    buffer_load_dwordx4 v[96:99], v224, s[28:31], 0 offen offset:64
    buffer_load_dwordx4 v[100:103], v224, s[28:31], 0 offen offset:128
    buffer_load_dwordx4 v[104:107], v224, s[28:31], 0 offen offset:192
    v_add_u32 v224, 24, v3
    v_min_u32 v224, 31, v224
    v_add_u32 v224, s63, v224
    v_lshlrev_b32 v224, 13, v224
    v_add_u32 v224, v224, v6
    v_add_u32 v224, 20971520, v224

    buffer_load_dwordx4 v[108:111], v224, s[28:31], 0 offen offset:0
    buffer_load_dwordx4 v[112:115], v224, s[28:31], 0 offen offset:64
    buffer_load_dwordx4 v[116:119], v224, s[28:31], 0 offen offset:128
    buffer_load_dwordx4 v[120:123], v224, s[28:31], 0 offen offset:192
    v_lshrrev_b32 v225, 4, v2
    v_and_b32 v226, 15, v2
    v_lshlrev_b32 v226, 4, v226

    v_add_u32 v224, 0, v225
    v_min_u32 v224, 31, v224
    v_add_u32 v224, s63, v224
    v_lshlrev_b32 v224, 13, v224
    v_add_u32 v224, v224, v226
    v_add_u32 v224, s20, v224
    v_add_u32 v224, 37748736, v224
    buffer_load_dwordx4 a[128:131], v224, s[28:31], 0 offen

    v_add_u32 v224, 4, v225
    v_min_u32 v224, 31, v224
    v_add_u32 v224, s63, v224
    v_lshlrev_b32 v224, 13, v224
    v_add_u32 v224, v224, v226
    v_add_u32 v224, s20, v224
    v_add_u32 v224, 37748736, v224
    buffer_load_dwordx4 a[132:135], v224, s[28:31], 0 offen

    v_add_u32 v224, 8, v225
    v_min_u32 v224, 31, v224
    v_add_u32 v224, s63, v224
    v_lshlrev_b32 v224, 13, v224
    v_add_u32 v224, v224, v226
    v_add_u32 v224, s20, v224
    v_add_u32 v224, 37748736, v224
    buffer_load_dwordx4 a[136:139], v224, s[28:31], 0 offen

    v_add_u32 v224, 12, v225
    v_min_u32 v224, 31, v224
    v_add_u32 v224, s63, v224
    v_lshlrev_b32 v224, 13, v224
    v_add_u32 v224, v224, v226
    v_add_u32 v224, s20, v224
    v_add_u32 v224, 37748736, v224
    buffer_load_dwordx4 a[140:143], v224, s[28:31], 0 offen

    v_add_u32 v224, 16, v225
    v_min_u32 v224, 31, v224
    v_add_u32 v224, s63, v224
    v_lshlrev_b32 v224, 13, v224
    v_add_u32 v224, v224, v226
    v_add_u32 v224, s20, v224
    v_add_u32 v224, 37748736, v224
    buffer_load_dwordx4 a[144:147], v224, s[28:31], 0 offen

    v_add_u32 v224, 20, v225
    v_min_u32 v224, 31, v224
    v_add_u32 v224, s63, v224
    v_lshlrev_b32 v224, 13, v224
    v_add_u32 v224, v224, v226
    v_add_u32 v224, s20, v224
    v_add_u32 v224, 37748736, v224
    buffer_load_dwordx4 a[148:151], v224, s[28:31], 0 offen

    v_add_u32 v224, 24, v225
    v_min_u32 v224, 31, v224
    v_add_u32 v224, s63, v224
    v_lshlrev_b32 v224, 13, v224
    v_add_u32 v224, v224, v226
    v_add_u32 v224, s20, v224
    v_add_u32 v224, 37748736, v224
    buffer_load_dwordx4 a[152:155], v224, s[28:31], 0 offen

    v_add_u32 v224, 28, v225
    v_min_u32 v224, 31, v224
    v_add_u32 v224, s63, v224
    v_lshlrev_b32 v224, 13, v224
    v_add_u32 v224, v224, v226
    v_add_u32 v224, s20, v224
    v_add_u32 v224, 37748736, v224
    buffer_load_dwordx4 a[156:159], v224, s[28:31], 0 offen

    v_add_u32 v224, 32, v225
    v_min_u32 v224, 31, v224
    v_add_u32 v224, s63, v224
    v_lshlrev_b32 v224, 13, v224
    v_add_u32 v224, v224, v226
    v_add_u32 v224, s20, v224
    v_add_u32 v224, 37748736, v224
    buffer_load_dwordx4 a[160:163], v224, s[28:31], 0 offen

    v_add_u32 v224, 36, v225
    v_min_u32 v224, 31, v224
    v_add_u32 v224, s63, v224
    v_lshlrev_b32 v224, 13, v224
    v_add_u32 v224, v224, v226
    v_add_u32 v224, s20, v224
    v_add_u32 v224, 37748736, v224
    buffer_load_dwordx4 a[164:167], v224, s[28:31], 0 offen

    s_lshl_b32 s22, s60, 5
    s_mul_i32 s23, s60, 196608
    s_add_u32 s23, s23, 89128960

    s_cmp_eq_u32 s60, 0
    s_cbranch_scc1 K3_PA0_3
    s_lshl_b32 s24, s60, 14
    s_add_u32 s24, s24, 88080384

    s_branch K3_PA_2_go
K3_PA_2:
    s_sleep 6
K3_PA_2_go:
    buffer_load_dwordx4 v[16:19], v5, s[28:31], s24 offen offset:0 sc1
    buffer_load_dwordx4 v[20:23], v5, s[28:31], s24 offen offset:64 sc1
    buffer_load_dwordx4 v[24:27], v5, s[28:31], s24 offen offset:128 sc1
    buffer_load_dwordx4 v[28:31], v5, s[28:31], s24 offen offset:192 sc1
    buffer_load_dwordx4 v[32:35], v5, s[28:31], s24 offen offset:256 sc1
    buffer_load_dwordx4 v[36:39], v5, s[28:31], s24 offen offset:320 sc1
    buffer_load_dwordx4 v[40:43], v5, s[28:31], s24 offen offset:384 sc1
    buffer_load_dwordx4 v[44:47], v5, s[28:31], s24 offen offset:448 sc1
    s_waitcnt vmcnt(0)
    v_max3_u32 v224, v16, v17, v18
    v_max3_u32 v224, v224, v19, v20
    v_max3_u32 v224, v224, v21, v22
    v_max3_u32 v224, v224, v23, v24
    v_max3_u32 v224, v224, v25, v26
    v_max3_u32 v224, v224, v27, v28
    v_max3_u32 v224, v224, v29, v30
    v_max3_u32 v224, v224, v31, v32
    v_max3_u32 v224, v224, v33, v34
    v_max3_u32 v224, v224, v35, v36
    v_max3_u32 v224, v224, v37, v38
    v_max3_u32 v224, v224, v39, v40
    v_max3_u32 v224, v224, v41, v42
    v_max3_u32 v224, v224, v43, v44
    v_max3_u32 v224, v224, v45, v46
    v_max3_u32 v224, v224, v47, v47
    v_cmp_eq_u32 vcc, -1, v224
    s_nop 3
    s_cbranch_vccnz K3_PA_2
    s_branch K3_PAD_4

K3_PA0_3:
    buffer_load_dwordx4 v[16:19], v5, s[48:51], 0 offen offset:0
    buffer_load_dwordx4 v[20:23], v5, s[48:51], 0 offen offset:64
    buffer_load_dwordx4 v[24:27], v5, s[48:51], 0 offen offset:128
    buffer_load_dwordx4 v[28:31], v5, s[48:51], 0 offen offset:192
    buffer_load_dwordx4 v[32:35], v5, s[48:51], 0 offen offset:256
    buffer_load_dwordx4 v[36:39], v5, s[48:51], 0 offen offset:320
    buffer_load_dwordx4 v[40:43], v5, s[48:51], 0 offen offset:384
    buffer_load_dwordx4 v[44:47], v5, s[48:51], 0 offen offset:448
    s_waitcnt vmcnt(0)
K3_PAD_4:
    v_mov_b32 v48, 0
    v_mov_b32 v49, 0
    v_mov_b32 v50, 0
    v_mov_b32 v51, 0
    v_mov_b32 v52, 0
    v_mov_b32 v53, 0
    v_mov_b32 v54, 0
    v_mov_b32 v55, 0
    v_mov_b32 v56, 0
    v_mov_b32 v57, 0
    v_mov_b32 v58, 0
    v_mov_b32 v59, 0
    s_nop 1
    v_mfma_f32_16x16x32_bf16 v[48:51], a[0:3], v[16:19], v[48:51]
    v_mfma_f32_16x16x32_bf16 v[52:55], a[4:7], v[16:19], v[52:55]
    v_mfma_f32_16x16x32_bf16 v[56:59], a[8:11], v[16:19], v[56:59]
    v_mfma_f32_16x16x32_bf16 v[48:51], a[12:15], v[20:23], v[48:51]
    v_mfma_f32_16x16x32_bf16 v[52:55], a[16:19], v[20:23], v[52:55]
    v_mfma_f32_16x16x32_bf16 v[56:59], a[20:23], v[20:23], v[56:59]
    v_mfma_f32_16x16x32_bf16 v[48:51], a[24:27], v[24:27], v[48:51]
    v_mfma_f32_16x16x32_bf16 v[52:55], a[28:31], v[24:27], v[52:55]
    v_mfma_f32_16x16x32_bf16 v[56:59], a[32:35], v[24:27], v[56:59]
    v_mfma_f32_16x16x32_bf16 v[48:51], a[36:39], v[28:31], v[48:51]
    v_mfma_f32_16x16x32_bf16 v[52:55], a[40:43], v[28:31], v[52:55]
    v_mfma_f32_16x16x32_bf16 v[56:59], a[44:47], v[28:31], v[56:59]
    v_mfma_f32_16x16x32_bf16 v[48:51], a[48:51], v[32:35], v[48:51]
    v_mfma_f32_16x16x32_bf16 v[52:55], a[52:55], v[32:35], v[52:55]
    v_mfma_f32_16x16x32_bf16 v[56:59], a[56:59], v[32:35], v[56:59]
    v_mfma_f32_16x16x32_bf16 v[48:51], a[60:63], v[36:39], v[48:51]
    v_mfma_f32_16x16x32_bf16 v[52:55], a[64:67], v[36:39], v[52:55]
    v_mfma_f32_16x16x32_bf16 v[56:59], a[68:71], v[36:39], v[56:59]
    v_mfma_f32_16x16x32_bf16 v[48:51], a[72:75], v[40:43], v[48:51]
    v_mfma_f32_16x16x32_bf16 v[52:55], a[76:79], v[40:43], v[52:55]
    v_mfma_f32_16x16x32_bf16 v[56:59], a[80:83], v[40:43], v[56:59]
    v_mfma_f32_16x16x32_bf16 v[48:51], a[84:87], v[44:47], v[48:51]
    v_mfma_f32_16x16x32_bf16 v[52:55], a[88:91], v[44:47], v[52:55]
    v_mfma_f32_16x16x32_bf16 v[56:59], a[92:95], v[44:47], v[56:59]
    s_nop 7
    s_nop 1
    s_mul_i32 s25, s18, 3072
    v_lshlrev_b32 v224, 4, v2
    v_add_u32 v224, s25, v224
    ds_write_b128 v224, v[48:51]
    ds_write_b128 v224, v[52:55] offset:1024
    ds_write_b128 v224, v[56:59] offset:2048
    s_waitcnt lgkmcnt(0)
    s_barrier

    s_cmp_ge_u32 s18, 3
    s_cbranch_scc1 K3_RD_5
    s_lshl_b32 s25, s18, 10
    v_lshlrev_b32 v224, 4, v2
    v_add_u32 v224, s25, v224
    ds_read_b128 v[48:51], v224
    ds_read_b128 v[52:55], v224 offset:3072
    ds_read_b128 v[56:59], v224 offset:6144
    ds_read_b128 v[228:231], v224 offset:9216
    s_waitcnt lgkmcnt(0)

    v_add_f32 v48, v48, v52
    v_add_f32 v56, v56, v228
    v_add_f32 v48, v48, v56

    v_add_f32 v49, v49, v53
    v_add_f32 v57, v57, v229
    v_add_f32 v49, v49, v57

    v_add_f32 v50, v50, v54
    v_add_f32 v58, v58, v230
    v_add_f32 v50, v50, v58

    v_add_f32 v51, v51, v55
    v_add_f32 v59, v59, v231
    v_add_f32 v51, v51, v59

    v_cvt_pk_bf16_f32 v224, v48, v49
    v_cvt_pk_bf16_f32 v225, v50, v51
    s_lshl_b32 s25, s18, 16
    s_add_u32 s25, s25, s23
    s_lshl_b32 s26, s17, 5
    s_add_u32 s26, s26, s20
    v_lshlrev_b32 v226, 13, v3
    v_lshl_add_u32 v226, v4, 3, v226
    v_add_u32 v226, s26, v226
    v_cmp_gt_u32 vcc, 8, v3
    s_and_saveexec_b64 s[52:53], vcc
    buffer_store_dwordx2 v[224:225], v226, s[28:31], s25 offen sc1
    s_mov_b64 exec, s[52:53]

K3_RD_5:
    v_lshrrev_b32 v225, 4, v2
    v_and_b32 v226, 15, v2
    v_lshlrev_b32 v226, 4, v226
    v_add_u32 v227, 8, v225
    v_mul_u32_u24 v227, 272, v227
    v_add_u32 v227, v227, v226
    v_add_u32 v227, s21, v227

    ds_write_b128 v227, a[128:131] offset:0
    ds_write_b128 v227, a[132:135] offset:1088
    ds_write_b128 v227, a[136:139] offset:2176
    ds_write_b128 v227, a[140:143] offset:3264
    ds_write_b128 v227, a[144:147] offset:4352
    ds_write_b128 v227, a[148:151] offset:5440
    ds_write_b128 v227, a[152:155] offset:6528
    ds_write_b128 v227, a[156:159] offset:7616
    ds_write_b128 v227, a[160:163] offset:8704
    ds_write_b128 v227, a[164:167] offset:9792
    v_lshlrev_b32 v224, 13, v8
    v_add_u32 v224, v224, v6
    v_subrev_u32 v225, 8, v3
    v_add_u32 v225, s22, v225
    v_lshlrev_b32 v225, 13, v225
    v_add_u32 v225, 20971520, v225
    v_lshlrev_b32 v226, 13, v3
    v_add_u32 v226, s23, v226
    v_add_u32 v226, 65536, v226
    v_cmp_gt_u32 vcc, 8, v3
    s_nop 1
    v_cndmask_b32 v225, v225, v226, vcc
    v_add_u32 v225, v225, v6
    v_lshrrev_b32 v226, 3, v2
    v_and_b32 v227, 7, v2
    v_lshlrev_b32 v227, 5, v227
    v_lshl_add_u32 v227, v226, 13, v227
    v_add_u32 v227, s20, v227
    v_add_u32 v227, 131072, v227

    s_branch K3_PB_6_go
K3_PB_6:
    s_sleep 6
K3_PB_6_go:
    buffer_load_dwordx4 v[60:63], v224, s[28:31], s23 offen offset:0 sc1
    buffer_load_dwordx4 v[64:67], v224, s[28:31], s23 offen offset:64 sc1
    buffer_load_dwordx4 v[68:71], v224, s[28:31], s23 offen offset:128 sc1
    buffer_load_dwordx4 v[72:75], v224, s[28:31], s23 offen offset:192 sc1
    buffer_load_dwordx4 v[76:79], v225, s[28:31], 0 offen offset:0 sc1
    buffer_load_dwordx4 v[80:83], v225, s[28:31], 0 offen offset:64 sc1
    buffer_load_dwordx4 v[84:87], v225, s[28:31], 0 offen offset:128 sc1
    buffer_load_dwordx4 v[88:91], v225, s[28:31], 0 offen offset:192 sc1
    buffer_load_dwordx4 v[208:211], v227, s[28:31], s23 offen sc1
    buffer_load_dwordx4 v[212:215], v227, s[28:31], s23 offen offset:16 sc1
    s_waitcnt vmcnt(0)

    v_max3_u32 v228, v60, v61, v62
    v_max3_u32 v228, v228, v63, v64
    v_max3_u32 v228, v228, v65, v66
    v_max3_u32 v228, v228, v67, v68
    v_max3_u32 v228, v228, v69, v70
    v_max3_u32 v228, v228, v71, v72
    v_max3_u32 v228, v228, v73, v74
    v_max3_u32 v228, v228, v75, v76
    v_max3_u32 v228, v228, v77, v78
    v_max3_u32 v228, v228, v79, v80
    v_max3_u32 v228, v228, v81, v82
    v_max3_u32 v228, v228, v83, v84
    v_max3_u32 v228, v228, v85, v86
    v_max3_u32 v228, v228, v87, v88
    v_max3_u32 v228, v228, v89, v90
    v_max3_u32 v228, v228, v91, v208
    v_max3_u32 v228, v228, v209, v210
    v_max3_u32 v228, v228, v211, v212
    v_max3_u32 v228, v228, v213, v214
    v_max3_u32 v228, v228, v215, v215
    v_cmp_eq_u32 vcc, -1, v228
    s_nop 3
    s_cbranch_vccnz K3_PB_6
    v_mul_u32_u24 v228, 272, v226
    v_and_b32 v229, 7, v2
    v_lshl_add_u32 v228, v229, 5, v228
    v_add_u32 v228, s21, v228
    ds_write_b128 v228, v[208:211]
    ds_write_b128 v228, v[212:215] offset:16

    v_mov_b32 v124, 0
    v_mov_b32 v125, 0
    v_mov_b32 v126, 0
    v_mov_b32 v127, 0
    v_mov_b32 v128, 0
    v_mov_b32 v129, 0
    v_mov_b32 v130, 0
    v_mov_b32 v131, 0
    v_mov_b32 v132, 0
    v_mov_b32 v133, 0
    v_mov_b32 v134, 0
    v_mov_b32 v135, 0
    s_nop 1
    v_mfma_f32_16x16x32_bf16 v[124:127], v[76:79], v[60:63], v[124:127]
    v_mfma_f32_16x16x32_bf16 v[128:131], v[92:95], v[60:63], v[128:131]
    v_mfma_f32_16x16x32_bf16 v[132:135], v[108:111], v[60:63], v[132:135]
    v_mfma_f32_16x16x32_bf16 v[124:127], v[80:83], v[64:67], v[124:127]
    v_mfma_f32_16x16x32_bf16 v[128:131], v[96:99], v[64:67], v[128:131]
    v_mfma_f32_16x16x32_bf16 v[132:135], v[112:115], v[64:67], v[132:135]
    v_mfma_f32_16x16x32_bf16 v[124:127], v[84:87], v[68:71], v[124:127]
    v_mfma_f32_16x16x32_bf16 v[128:131], v[100:103], v[68:71], v[128:131]
    v_mfma_f32_16x16x32_bf16 v[132:135], v[116:119], v[68:71], v[132:135]
    v_mfma_f32_16x16x32_bf16 v[124:127], v[88:91], v[72:75], v[124:127]
    v_mfma_f32_16x16x32_bf16 v[128:131], v[104:107], v[72:75], v[128:131]
    v_mfma_f32_16x16x32_bf16 v[132:135], v[120:123], v[72:75], v[132:135]
    s_nop 7
    s_nop 1
    s_mov_b32 s25, 0x3db504f3
    s_mov_b32 s26, 0xce6e6b28
    s_mov_b32 s27, 0x3fb8aa3b
    v_mov_b32 v226, 0xff800000

    v_cvt_pk_bf16_f32 v228, v124, v125
    v_cvt_pk_bf16_f32 v229, v126, v127
    v_lshlrev_b32 v124, 16, v228
    v_and_b32 v125, 0xffff0000, v228
    v_lshlrev_b32 v126, 16, v229
    v_and_b32 v127, 0xffff0000, v229

    v_mul_f32 v124, s25, v124
    v_mul_f32 v125, s25, v125
    v_mul_f32 v126, s25, v126
    v_mul_f32 v127, s25, v127
    v_cvt_pk_bf16_f32 v228, v124, v125
    v_cvt_pk_bf16_f32 v229, v126, v127
    v_lshlrev_b32 v124, 16, v228
    v_and_b32 v125, 0xffff0000, v228
    v_lshlrev_b32 v126, 16, v229
    v_and_b32 v127, 0xffff0000, v229

    v_max_f32 v226, v226, v124
    v_max_f32 v226, v226, v125
    v_max_f32 v226, v226, v126
    v_max_f32 v226, v226, v127
    v_cvt_pk_bf16_f32 v228, v128, v129
    v_cvt_pk_bf16_f32 v229, v130, v131
    v_lshlrev_b32 v128, 16, v228
    v_and_b32 v129, 0xffff0000, v228
    v_lshlrev_b32 v130, 16, v229
    v_and_b32 v131, 0xffff0000, v229

    v_mul_f32 v128, s25, v128
    v_mul_f32 v129, s25, v129
    v_mul_f32 v130, s25, v130
    v_mul_f32 v131, s25, v131
    v_cvt_pk_bf16_f32 v228, v128, v129
    v_cvt_pk_bf16_f32 v229, v130, v131
    v_lshlrev_b32 v128, 16, v228
    v_and_b32 v129, 0xffff0000, v228
    v_lshlrev_b32 v130, 16, v229
    v_and_b32 v131, 0xffff0000, v229

    v_max_f32 v226, v226, v128
    v_max_f32 v226, v226, v129
    v_max_f32 v226, v226, v130
    v_max_f32 v226, v226, v131
    v_cvt_pk_bf16_f32 v228, v132, v133
    v_cvt_pk_bf16_f32 v229, v134, v135
    v_lshlrev_b32 v132, 16, v228
    v_and_b32 v133, 0xffff0000, v228
    v_lshlrev_b32 v134, 16, v229
    v_and_b32 v135, 0xffff0000, v229

    v_mul_f32 v132, s25, v132
    v_mul_f32 v133, s25, v133
    v_mul_f32 v134, s25, v134
    v_mul_f32 v135, s25, v135
    v_cvt_pk_bf16_f32 v228, v132, v133
    v_cvt_pk_bf16_f32 v229, v134, v135
    v_lshlrev_b32 v132, 16, v228
    v_and_b32 v133, 0xffff0000, v228
    v_lshlrev_b32 v134, 16, v229
    v_and_b32 v135, 0xffff0000, v229

    v_cmp_gt_u32 vcc, 2, v4
    v_mov_b32 v228, s26
    s_nop 0

    v_cndmask_b32 v132, v228, v132, vcc
    v_cndmask_b32 v133, v228, v133, vcc
    v_cndmask_b32 v134, v228, v134, vcc
    v_cndmask_b32 v135, v228, v135, vcc
    v_max_f32 v226, v226, v132
    v_max_f32 v226, v226, v133
    v_max_f32 v226, v226, v134
    v_max_f32 v226, v226, v135
    v_xor_b32 v227, 16, v2
    v_lshlrev_b32 v227, 2, v227
    ds_bpermute_b32 v228, v227, v226
    s_waitcnt lgkmcnt(0)
    v_max_f32 v226, v226, v228
    v_xor_b32 v230, 32, v2
    v_lshlrev_b32 v230, 2, v230
    ds_bpermute_b32 v228, v230, v226
    s_waitcnt lgkmcnt(0)
    v_max_f32 v226, v226, v228
    v_mov_b32 v225, 0

    v_sub_f32 v124, v124, v226
    v_mul_f32 v124, s27, v124
    v_exp_f32 v124, v124
    s_nop 0
    v_add_f32 v225, v225, v124

    v_sub_f32 v125, v125, v226
    v_mul_f32 v125, s27, v125
    v_exp_f32 v125, v125
    s_nop 0
    v_add_f32 v225, v225, v125

    v_sub_f32 v126, v126, v226
    v_mul_f32 v126, s27, v126
    v_exp_f32 v126, v126
    s_nop 0
    v_add_f32 v225, v225, v126

    v_sub_f32 v127, v127, v226
    v_mul_f32 v127, s27, v127
    v_exp_f32 v127, v127
    s_nop 0
    v_add_f32 v225, v225, v127

    v_sub_f32 v128, v128, v226
    v_mul_f32 v128, s27, v128
    v_exp_f32 v128, v128
    s_nop 0
    v_add_f32 v225, v225, v128

    v_sub_f32 v129, v129, v226
    v_mul_f32 v129, s27, v129
    v_exp_f32 v129, v129
    s_nop 0
    v_add_f32 v225, v225, v129

    v_sub_f32 v130, v130, v226
    v_mul_f32 v130, s27, v130
    v_exp_f32 v130, v130
    s_nop 0
    v_add_f32 v225, v225, v130

    v_sub_f32 v131, v131, v226
    v_mul_f32 v131, s27, v131
    v_exp_f32 v131, v131
    s_nop 0
    v_add_f32 v225, v225, v131

    v_sub_f32 v132, v132, v226
    v_mul_f32 v132, s27, v132
    v_exp_f32 v132, v132
    s_nop 0
    v_add_f32 v225, v225, v132

    v_sub_f32 v133, v133, v226
    v_mul_f32 v133, s27, v133
    v_exp_f32 v133, v133
    s_nop 0
    v_add_f32 v225, v225, v133

    v_sub_f32 v134, v134, v226
    v_mul_f32 v134, s27, v134
    v_exp_f32 v134, v134
    s_nop 0
    v_add_f32 v225, v225, v134

    v_sub_f32 v135, v135, v226
    v_mul_f32 v135, s27, v135
    v_exp_f32 v135, v135
    s_nop 0
    v_add_f32 v225, v225, v135

    ds_bpermute_b32 v228, v227, v225
    s_waitcnt lgkmcnt(0)
    v_add_f32 v225, v225, v228
    ds_bpermute_b32 v228, v230, v225
    s_waitcnt lgkmcnt(0)
    v_add_f32 v225, v225, v228
    v_rcp_f32 v225, v225
    s_nop 0

    v_mul_f32 v124, v124, v225
    v_mul_f32 v125, v125, v225
    v_mul_f32 v126, v126, v225
    v_mul_f32 v127, v127, v225
    v_mul_f32 v128, v128, v225
    v_mul_f32 v129, v129, v225
    v_mul_f32 v130, v130, v225
    v_mul_f32 v131, v131, v225
    v_mul_f32 v132, v132, v225
    v_mul_f32 v133, v133, v225
    v_mul_f32 v134, v134, v225
    v_mul_f32 v135, v135, v225
    v_cvt_pk_bf16_f32 v136, v124, v125
    v_cvt_pk_bf16_f32 v137, v126, v127
    v_cvt_pk_bf16_f32 v138, v128, v129
    v_cvt_pk_bf16_f32 v139, v130, v131
    v_cvt_pk_bf16_f32 v140, v132, v133
    v_cvt_pk_bf16_f32 v141, v134, v135
    v_mov_b32 v142, 0
    v_mov_b32 v143, 0
    v_mov_b32 v150, 0
    v_mov_b32 v151, 0
    s_waitcnt lgkmcnt(0)

    ds_read_b64_tr_b16 v[144:145], v7 offset:0
    ds_read_b64_tr_b16 v[146:147], v7 offset:4352
    ds_read_b64_tr_b16 v[148:149], v7 offset:8704
    v_mov_b32 v152, 0
    v_mov_b32 v153, 0
    v_mov_b32 v154, 0
    v_mov_b32 v155, 0
    s_waitcnt lgkmcnt(0)
    s_nop 1
    v_mfma_f32_16x16x32_bf16 v[152:155], v[144:147], v[136:139], v[152:155]
    v_mfma_f32_16x16x32_bf16 v[152:155], v[148:151], v[140:143], v[152:155]
    s_nop 7

    ds_read_b64_tr_b16 v[144:145], v7 offset:32
    ds_read_b64_tr_b16 v[146:147], v7 offset:4384
    ds_read_b64_tr_b16 v[148:149], v7 offset:8736
    v_mov_b32 v156, 0
    v_mov_b32 v157, 0
    v_mov_b32 v158, 0
    v_mov_b32 v159, 0
    s_waitcnt lgkmcnt(0)
    s_nop 1
    v_mfma_f32_16x16x32_bf16 v[156:159], v[144:147], v[136:139], v[156:159]
    v_mfma_f32_16x16x32_bf16 v[156:159], v[148:151], v[140:143], v[156:159]
    s_nop 7

    ds_read_b64_tr_b16 v[144:145], v7 offset:64
    ds_read_b64_tr_b16 v[146:147], v7 offset:4416
    ds_read_b64_tr_b16 v[148:149], v7 offset:8768
    v_mov_b32 v160, 0
    v_mov_b32 v161, 0
    v_mov_b32 v162, 0
    v_mov_b32 v163, 0
    s_waitcnt lgkmcnt(0)
    s_nop 1
    v_mfma_f32_16x16x32_bf16 v[160:163], v[144:147], v[136:139], v[160:163]
    v_mfma_f32_16x16x32_bf16 v[160:163], v[148:151], v[140:143], v[160:163]
    s_nop 7

    ds_read_b64_tr_b16 v[144:145], v7 offset:96
    ds_read_b64_tr_b16 v[146:147], v7 offset:4448
    ds_read_b64_tr_b16 v[148:149], v7 offset:8800
    v_mov_b32 v164, 0
    v_mov_b32 v165, 0
    v_mov_b32 v166, 0
    v_mov_b32 v167, 0
    s_waitcnt lgkmcnt(0)
    s_nop 1
    v_mfma_f32_16x16x32_bf16 v[164:167], v[144:147], v[136:139], v[164:167]
    v_mfma_f32_16x16x32_bf16 v[164:167], v[148:151], v[140:143], v[164:167]
    s_nop 7

    ds_read_b64_tr_b16 v[144:145], v7 offset:128
    ds_read_b64_tr_b16 v[146:147], v7 offset:4480
    ds_read_b64_tr_b16 v[148:149], v7 offset:8832
    v_mov_b32 v168, 0
    v_mov_b32 v169, 0
    v_mov_b32 v170, 0
    v_mov_b32 v171, 0
    s_waitcnt lgkmcnt(0)
    s_nop 1
    v_mfma_f32_16x16x32_bf16 v[168:171], v[144:147], v[136:139], v[168:171]
    v_mfma_f32_16x16x32_bf16 v[168:171], v[148:151], v[140:143], v[168:171]
    s_nop 7

    ds_read_b64_tr_b16 v[144:145], v7 offset:160
    ds_read_b64_tr_b16 v[146:147], v7 offset:4512
    ds_read_b64_tr_b16 v[148:149], v7 offset:8864
    v_mov_b32 v172, 0
    v_mov_b32 v173, 0
    v_mov_b32 v174, 0
    v_mov_b32 v175, 0
    s_waitcnt lgkmcnt(0)
    s_nop 1
    v_mfma_f32_16x16x32_bf16 v[172:175], v[144:147], v[136:139], v[172:175]
    v_mfma_f32_16x16x32_bf16 v[172:175], v[148:151], v[140:143], v[172:175]
    s_nop 7

    ds_read_b64_tr_b16 v[144:145], v7 offset:192
    ds_read_b64_tr_b16 v[146:147], v7 offset:4544
    ds_read_b64_tr_b16 v[148:149], v7 offset:8896
    v_mov_b32 v176, 0
    v_mov_b32 v177, 0
    v_mov_b32 v178, 0
    v_mov_b32 v179, 0
    s_waitcnt lgkmcnt(0)
    s_nop 1
    v_mfma_f32_16x16x32_bf16 v[176:179], v[144:147], v[136:139], v[176:179]
    v_mfma_f32_16x16x32_bf16 v[176:179], v[148:151], v[140:143], v[176:179]
    s_nop 7

    ds_read_b64_tr_b16 v[144:145], v7 offset:224
    ds_read_b64_tr_b16 v[146:147], v7 offset:4576
    ds_read_b64_tr_b16 v[148:149], v7 offset:8928
    v_mov_b32 v180, 0
    v_mov_b32 v181, 0
    v_mov_b32 v182, 0
    v_mov_b32 v183, 0
    s_waitcnt lgkmcnt(0)
    s_nop 1
    v_mfma_f32_16x16x32_bf16 v[180:183], v[144:147], v[136:139], v[180:183]
    v_mfma_f32_16x16x32_bf16 v[180:183], v[148:151], v[140:143], v[180:183]
    s_nop 7

    s_nop 3
    s_cmp_eq_u32 s60, 63
    s_cbranch_scc1 K3_END

    v_cvt_pk_bf16_f32 v184, v152, v153
    v_cvt_pk_bf16_f32 v185, v154, v155
    v_cvt_pk_bf16_f32 v186, v156, v157
    v_cvt_pk_bf16_f32 v187, v158, v159

    v_cvt_pk_bf16_f32 v188, v160, v161
    v_cvt_pk_bf16_f32 v189, v162, v163
    v_cvt_pk_bf16_f32 v190, v164, v165
    v_cvt_pk_bf16_f32 v191, v166, v167

    v_cvt_pk_bf16_f32 v192, v168, v169
    v_cvt_pk_bf16_f32 v193, v170, v171
    v_cvt_pk_bf16_f32 v194, v172, v173
    v_cvt_pk_bf16_f32 v195, v174, v175

    v_cvt_pk_bf16_f32 v196, v176, v177
    v_cvt_pk_bf16_f32 v197, v178, v179
    v_cvt_pk_bf16_f32 v198, v180, v181
    v_cvt_pk_bf16_f32 v199, v182, v183

    v_mov_b32 v200, 0
    v_mov_b32 v201, 0
    v_mov_b32 v202, 0
    v_mov_b32 v203, 0
    v_mov_b32 v204, 0
    v_mov_b32 v205, 0
    v_mov_b32 v206, 0
    v_mov_b32 v207, 0
    s_nop 1
    v_mfma_f32_16x16x32_bf16 v[200:203], a[96:99], v[184:187], v[200:203]
    v_mfma_f32_16x16x32_bf16 v[204:207], a[112:115], v[184:187], v[204:207]
    v_mfma_f32_16x16x32_bf16 v[200:203], a[100:103], v[188:191], v[200:203]
    v_mfma_f32_16x16x32_bf16 v[204:207], a[116:119], v[188:191], v[204:207]
    v_mfma_f32_16x16x32_bf16 v[200:203], a[104:107], v[192:195], v[200:203]
    v_mfma_f32_16x16x32_bf16 v[204:207], a[120:123], v[192:195], v[204:207]
    v_mfma_f32_16x16x32_bf16 v[200:203], a[108:111], v[196:199], v[200:203]
    v_mfma_f32_16x16x32_bf16 v[204:207], a[124:127], v[196:199], v[204:207]
    s_nop 7
    s_nop 1
    s_add_u32 s61, s60, 1
    s_lshl_b32 s25, s17, 18
    s_add_u32 s25, s25, 102760448
    s_lshl_b32 s26, s18, 3
    v_add_u32 v224, s26, v4
    v_lshlrev_b32 v224, 13, v224
    v_lshl_add_u32 v224, v3, 5, v224
    s_lshl_b32 s26, s16, 8
    v_add_u32 v224, s26, v224
    v_cmp_gt_u32 vcc, 8, v3
    s_and_saveexec_b64 s[52:53], vcc

    v_mov_b32 v216, v200
    v_mov_b32 v217, s61
    v_mov_b32 v218, v201
    v_mov_b32 v219, s61
    v_mov_b32 v220, v202
    v_mov_b32 v221, s61
    v_mov_b32 v222, v203
    v_mov_b32 v223, s61
    buffer_store_dwordx4 v[216:219], v224, s[28:31], s25 offen offset:0 sc1
    buffer_store_dwordx4 v[220:223], v224, s[28:31], s25 offen offset:16 sc1
    s_nop 1

    v_add_u32 v224, 32768, v224
    v_mov_b32 v216, v204
    v_mov_b32 v217, s61
    v_mov_b32 v218, v205
    v_mov_b32 v219, s61
    v_mov_b32 v220, v206
    v_mov_b32 v221, s61
    v_mov_b32 v222, v207
    v_mov_b32 v223, s61
    buffer_store_dwordx4 v[216:219], v224, s[28:31], s25 offen offset:0 sc1
    buffer_store_dwordx4 v[220:223], v224, s[28:31], s25 offen offset:16 sc1
    s_nop 1

    s_mov_b64 exec, s[52:53]
    s_lshl_b32 s26, s16, 13
    s_add_u32 s25, s25, s26
    v_lshlrev_b32 v224, 5, v0

    s_branch K3_PC_8_go
K3_PC_8:
    s_sleep 6
K3_PC_8_go:
    buffer_load_dwordx4 v[216:219], v224, s[28:31], s25 offen sc1
    buffer_load_dwordx4 v[220:223], v224, s[28:31], s25 offen offset:16 sc1
    s_waitcnt vmcnt(0)
    v_xor_b32 v225, s61, v217
    v_xor_b32 v226, s61, v219
    v_or_b32 v225, v225, v226
    v_xor_b32 v226, s61, v221
    v_or_b32 v225, v225, v226
    v_xor_b32 v226, s61, v223
    v_or_b32 v225, v225, v226
    v_cmp_ne_u32 vcc, 0, v225
    s_nop 3
    s_cbranch_vccnz K3_PC_8

    v_xor_b32 v227, 8, v2
    v_lshlrev_b32 v227, 2, v227
    ds_bpermute_b32 v228, v227, v216
    ds_bpermute_b32 v229, v227, v218
    ds_bpermute_b32 v230, v227, v220
    ds_bpermute_b32 v231, v227, v222
    s_waitcnt lgkmcnt(0)
    v_add_f32 v216, v216, v228
    v_add_f32 v218, v218, v229
    v_add_f32 v220, v220, v230
    v_add_f32 v222, v222, v231

    v_xor_b32 v227, 16, v2
    v_lshlrev_b32 v227, 2, v227
    ds_bpermute_b32 v228, v227, v216
    ds_bpermute_b32 v229, v227, v218
    ds_bpermute_b32 v230, v227, v220
    ds_bpermute_b32 v231, v227, v222
    s_waitcnt lgkmcnt(0)
    v_add_f32 v216, v216, v228
    v_add_f32 v218, v218, v229
    v_add_f32 v220, v220, v230
    v_add_f32 v222, v222, v231

    v_xor_b32 v227, 32, v2
    v_lshlrev_b32 v227, 2, v227
    ds_bpermute_b32 v228, v227, v216
    ds_bpermute_b32 v229, v227, v218
    ds_bpermute_b32 v230, v227, v220
    ds_bpermute_b32 v231, v227, v222
    s_waitcnt lgkmcnt(0)
    v_add_f32 v216, v216, v228
    v_add_f32 v218, v218, v229
    v_add_f32 v220, v220, v230
    v_add_f32 v222, v222, v231

    v_mov_b32 v228, v216
    v_mov_b32 v229, v218
    v_mov_b32 v230, v220
    v_mov_b32 v231, v222
    s_lshl_b32 s26, s18, 7
    v_lshlrev_b32 v224, 4, v2
    v_add_u32 v224, s26, v224
    v_add_u32 v224, 12288, v224
    v_cmp_gt_u32 vcc, 8, v2
    s_and_saveexec_b64 s[52:53], vcc
    ds_write_b128 v224, v[228:231]
    s_mov_b64 exec, s[52:53]
    s_waitcnt lgkmcnt(0)
    s_barrier

    s_cmp_lg_u32 s18, 0
    s_cbranch_scc1 K3_CD_9
    v_lshlrev_b32 v224, 4, v2
    v_add_u32 v224, 12288, v224
    v_cmp_gt_u32 vcc, 8, v2
    s_and_saveexec_b64 s[52:53], vcc
    ds_read_b128 v[216:219], v224
    ds_read_b128 v[220:223], v224 offset:128
    ds_read_b128 v[228:231], v224 offset:256
    ds_read_b128 v[200:203], v224 offset:384
    s_waitcnt lgkmcnt(0)

    v_add_f32 v216, v216, v220
    v_add_f32 v228, v228, v200
    v_add_f32 v216, v216, v228

    v_add_f32 v217, v217, v221
    v_add_f32 v229, v229, v201
    v_add_f32 v217, v217, v229

    v_add_f32 v218, v218, v222
    v_add_f32 v230, v230, v202
    v_add_f32 v218, v218, v230

    v_add_f32 v219, v219, v223
    v_add_f32 v231, v231, v203
    v_add_f32 v219, v219, v231

    v_cvt_pk_bf16_f32 v228, v216, v217
    v_cvt_pk_bf16_f32 v229, v218, v219
    s_lshl_b32 s25, s61, 14
    s_add_u32 s25, s25, 88080384
    s_lshl_b32 s26, s17, 8
    s_lshl_b32 s27, s16, 3
    s_add_u32 s26, s26, s27
    v_lshlrev_b32 v224, 11, v2
    v_add_u32 v224, s26, v224
    buffer_store_dwordx2 v[228:229], v224, s[28:31], s25 offen sc1
    s_mov_b64 exec, s[52:53]

K3_CD_9:
    s_add_u32 s60, s60, 1
    s_branch K3_STEP

K3_END:
    s_endpgm
.globl k4_attn_kernel
.p2align 8
.type k4_attn_kernel,@function
k4_attn_kernel:
    s_cmp_ge_u32 s2, 512
    s_cbranch_scc1 K4_END
    s_load_dwordx2 s[12:13], s[0:1], 112
    s_waitcnt lgkmcnt(0)

    s_mov_b32 s28, s12
    s_and_b32 s29, s13, 0xffff
    s_mov_b32 s30, 268435456
    s_mov_b32 s31, 0x00020000

    v_lshrrev_b32 v1, 6, v0
    v_and_b32 v2, 63, v0
    s_nop 0
    v_readfirstlane_b32 s16, v1
    s_lshl_b32 s17, s2, 2
    s_add_u32 s17, s17, s16
    s_and_b32 s18, s17, 31
    s_lshr_b32 s19, s17, 5
    s_mul_i32 s20, s16, 13056
    v_and_b32 v3, 15, v2
    v_lshrrev_b32 v4, 4, v2
    s_lshl_b32 s21, s19, 5
    v_add_u32 v5, s21, v3
    v_lshlrev_b32 v5, 13, v5
    s_lshl_b32 s22, s18, 8
    v_lshl_add_u32 v6, v4, 4, s22
    v_add_u32 v5, v5, v6
    v_add_u32 v5, 4194304, v5

    buffer_load_dwordx4 v[16:19], v5, s[28:31], 0 offen offset:0
    buffer_load_dwordx4 v[20:23], v5, s[28:31], 0 offen offset:64
    buffer_load_dwordx4 v[24:27], v5, s[28:31], 0 offen offset:128
    buffer_load_dwordx4 v[28:31], v5, s[28:31], 0 offen offset:192
    v_add_u32 v5, 131072, v5
    buffer_load_dwordx4 v[32:35], v5, s[28:31], 0 offen offset:0
    buffer_load_dwordx4 v[36:39], v5, s[28:31], 0 offen offset:64
    buffer_load_dwordx4 v[40:43], v5, s[28:31], 0 offen offset:128
    buffer_load_dwordx4 v[44:47], v5, s[28:31], 0 offen offset:192
    s_mul_i32 s23, s19, 196608
    s_add_u32 s23, s23, 89194496

    v_add_u32 v7, 0, v3
    v_min_u32 v7, 39, v7
    v_subrev_u32 v8, 8, v7
    v_add_u32 v8, s21, v8
    v_lshlrev_b32 v8, 13, v8
    v_add_u32 v8, 20971520, v8
    v_lshlrev_b32 v9, 13, v7
    v_add_u32 v9, s23, v9
    v_cmp_gt_u32 vcc, 8, v7
    s_nop 1
    v_cndmask_b32 v8, v8, v9, vcc
    v_add_u32 v8, v8, v6

    buffer_load_dwordx4 v[48:51], v8, s[28:31], 0 offen offset:0
    buffer_load_dwordx4 v[52:55], v8, s[28:31], 0 offen offset:64
    buffer_load_dwordx4 v[56:59], v8, s[28:31], 0 offen offset:128
    buffer_load_dwordx4 v[60:63], v8, s[28:31], 0 offen offset:192
    v_add_u32 v7, 16, v3
    v_min_u32 v7, 39, v7
    v_subrev_u32 v8, 8, v7
    v_add_u32 v8, s21, v8
    v_lshlrev_b32 v8, 13, v8
    v_add_u32 v8, 20971520, v8
    v_lshlrev_b32 v9, 13, v7
    v_add_u32 v9, s23, v9
    v_cmp_gt_u32 vcc, 8, v7
    s_nop 1
    v_cndmask_b32 v8, v8, v9, vcc
    v_add_u32 v8, v8, v6

    buffer_load_dwordx4 v[64:67], v8, s[28:31], 0 offen offset:0
    buffer_load_dwordx4 v[68:71], v8, s[28:31], 0 offen offset:64
    buffer_load_dwordx4 v[72:75], v8, s[28:31], 0 offen offset:128
    buffer_load_dwordx4 v[76:79], v8, s[28:31], 0 offen offset:192
    v_add_u32 v7, 32, v3
    v_min_u32 v7, 39, v7
    v_subrev_u32 v8, 8, v7
    v_add_u32 v8, s21, v8
    v_lshlrev_b32 v8, 13, v8
    v_add_u32 v8, 20971520, v8
    v_lshlrev_b32 v9, 13, v7
    v_add_u32 v9, s23, v9
    v_cmp_gt_u32 vcc, 8, v7
    s_nop 1
    v_cndmask_b32 v8, v8, v9, vcc
    v_add_u32 v8, v8, v6

    buffer_load_dwordx4 v[80:83], v8, s[28:31], 0 offen offset:0
    buffer_load_dwordx4 v[84:87], v8, s[28:31], 0 offen offset:64
    buffer_load_dwordx4 v[88:91], v8, s[28:31], 0 offen offset:128
    buffer_load_dwordx4 v[92:95], v8, s[28:31], 0 offen offset:192
    s_add_u32 s24, s23, 65536
    v_lshrrev_b32 v10, 4, v2
    v_and_b32 v11, 15, v2
    v_lshlrev_b32 v11, 4, v11
    v_add_u32 v11, s22, v11

    v_add_u32 v7, 0, v10
    v_mul_u32_u24 v12, 272, v7
    v_min_u32 v7, 39, v7
    v_subrev_u32 v8, 8, v7
    v_add_u32 v8, s21, v8
    v_lshlrev_b32 v8, 13, v8
    v_add_u32 v8, 37748736, v8
    v_lshlrev_b32 v9, 13, v7
    v_add_u32 v9, s24, v9
    v_cmp_gt_u32 vcc, 8, v7
    s_nop 1
    v_cndmask_b32 v8, v8, v9, vcc
    v_add_u32 v8, v8, v11
    buffer_load_dwordx4 v[144:147], v8, s[28:31], 0 offen
    v_and_b32 v13, 15, v2
    v_lshl_add_u32 v12, v13, 4, v12
    v_add_u32 v12, s20, v12
    s_waitcnt vmcnt(0)
    ds_write_b128 v12, v[144:147]

    v_add_u32 v7, 4, v10
    v_mul_u32_u24 v12, 272, v7
    v_min_u32 v7, 39, v7
    v_subrev_u32 v8, 8, v7
    v_add_u32 v8, s21, v8
    v_lshlrev_b32 v8, 13, v8
    v_add_u32 v8, 37748736, v8
    v_lshlrev_b32 v9, 13, v7
    v_add_u32 v9, s24, v9
    v_cmp_gt_u32 vcc, 8, v7
    s_nop 1
    v_cndmask_b32 v8, v8, v9, vcc
    v_add_u32 v8, v8, v11
    buffer_load_dwordx4 v[144:147], v8, s[28:31], 0 offen
    v_and_b32 v13, 15, v2
    v_lshl_add_u32 v12, v13, 4, v12
    v_add_u32 v12, s20, v12
    s_waitcnt vmcnt(0)
    ds_write_b128 v12, v[144:147]

    v_add_u32 v7, 8, v10
    v_mul_u32_u24 v12, 272, v7
    v_min_u32 v7, 39, v7
    v_subrev_u32 v8, 8, v7
    v_add_u32 v8, s21, v8
    v_lshlrev_b32 v8, 13, v8
    v_add_u32 v8, 37748736, v8
    v_lshlrev_b32 v9, 13, v7
    v_add_u32 v9, s24, v9
    v_cmp_gt_u32 vcc, 8, v7
    s_nop 1
    v_cndmask_b32 v8, v8, v9, vcc
    v_add_u32 v8, v8, v11
    buffer_load_dwordx4 v[144:147], v8, s[28:31], 0 offen
    v_and_b32 v13, 15, v2
    v_lshl_add_u32 v12, v13, 4, v12
    v_add_u32 v12, s20, v12
    s_waitcnt vmcnt(0)
    ds_write_b128 v12, v[144:147]

    v_add_u32 v7, 12, v10
    v_mul_u32_u24 v12, 272, v7
    v_min_u32 v7, 39, v7
    v_subrev_u32 v8, 8, v7
    v_add_u32 v8, s21, v8
    v_lshlrev_b32 v8, 13, v8
    v_add_u32 v8, 37748736, v8
    v_lshlrev_b32 v9, 13, v7
    v_add_u32 v9, s24, v9
    v_cmp_gt_u32 vcc, 8, v7
    s_nop 1
    v_cndmask_b32 v8, v8, v9, vcc
    v_add_u32 v8, v8, v11
    buffer_load_dwordx4 v[144:147], v8, s[28:31], 0 offen
    v_and_b32 v13, 15, v2
    v_lshl_add_u32 v12, v13, 4, v12
    v_add_u32 v12, s20, v12
    s_waitcnt vmcnt(0)
    ds_write_b128 v12, v[144:147]

    v_add_u32 v7, 16, v10
    v_mul_u32_u24 v12, 272, v7
    v_min_u32 v7, 39, v7
    v_subrev_u32 v8, 8, v7
    v_add_u32 v8, s21, v8
    v_lshlrev_b32 v8, 13, v8
    v_add_u32 v8, 37748736, v8
    v_lshlrev_b32 v9, 13, v7
    v_add_u32 v9, s24, v9
    v_cmp_gt_u32 vcc, 8, v7
    s_nop 1
    v_cndmask_b32 v8, v8, v9, vcc
    v_add_u32 v8, v8, v11
    buffer_load_dwordx4 v[144:147], v8, s[28:31], 0 offen
    v_and_b32 v13, 15, v2
    v_lshl_add_u32 v12, v13, 4, v12
    v_add_u32 v12, s20, v12
    s_waitcnt vmcnt(0)
    ds_write_b128 v12, v[144:147]

    v_add_u32 v7, 20, v10
    v_mul_u32_u24 v12, 272, v7
    v_min_u32 v7, 39, v7
    v_subrev_u32 v8, 8, v7
    v_add_u32 v8, s21, v8
    v_lshlrev_b32 v8, 13, v8
    v_add_u32 v8, 37748736, v8
    v_lshlrev_b32 v9, 13, v7
    v_add_u32 v9, s24, v9
    v_cmp_gt_u32 vcc, 8, v7
    s_nop 1
    v_cndmask_b32 v8, v8, v9, vcc
    v_add_u32 v8, v8, v11
    buffer_load_dwordx4 v[144:147], v8, s[28:31], 0 offen
    v_and_b32 v13, 15, v2
    v_lshl_add_u32 v12, v13, 4, v12
    v_add_u32 v12, s20, v12
    s_waitcnt vmcnt(0)
    ds_write_b128 v12, v[144:147]

    v_add_u32 v7, 24, v10
    v_mul_u32_u24 v12, 272, v7
    v_min_u32 v7, 39, v7
    v_subrev_u32 v8, 8, v7
    v_add_u32 v8, s21, v8
    v_lshlrev_b32 v8, 13, v8
    v_add_u32 v8, 37748736, v8
    v_lshlrev_b32 v9, 13, v7
    v_add_u32 v9, s24, v9
    v_cmp_gt_u32 vcc, 8, v7
    s_nop 1
    v_cndmask_b32 v8, v8, v9, vcc
    v_add_u32 v8, v8, v11
    buffer_load_dwordx4 v[144:147], v8, s[28:31], 0 offen
    v_and_b32 v13, 15, v2
    v_lshl_add_u32 v12, v13, 4, v12
    v_add_u32 v12, s20, v12
    s_waitcnt vmcnt(0)
    ds_write_b128 v12, v[144:147]

    v_add_u32 v7, 28, v10
    v_mul_u32_u24 v12, 272, v7
    v_min_u32 v7, 39, v7
    v_subrev_u32 v8, 8, v7
    v_add_u32 v8, s21, v8
    v_lshlrev_b32 v8, 13, v8
    v_add_u32 v8, 37748736, v8
    v_lshlrev_b32 v9, 13, v7
    v_add_u32 v9, s24, v9
    v_cmp_gt_u32 vcc, 8, v7
    s_nop 1
    v_cndmask_b32 v8, v8, v9, vcc
    v_add_u32 v8, v8, v11
    buffer_load_dwordx4 v[144:147], v8, s[28:31], 0 offen
    v_and_b32 v13, 15, v2
    v_lshl_add_u32 v12, v13, 4, v12
    v_add_u32 v12, s20, v12
    s_waitcnt vmcnt(0)
    ds_write_b128 v12, v[144:147]

    v_add_u32 v7, 32, v10
    v_mul_u32_u24 v12, 272, v7
    v_min_u32 v7, 39, v7
    v_subrev_u32 v8, 8, v7
    v_add_u32 v8, s21, v8
    v_lshlrev_b32 v8, 13, v8
    v_add_u32 v8, 37748736, v8
    v_lshlrev_b32 v9, 13, v7
    v_add_u32 v9, s24, v9
    v_cmp_gt_u32 vcc, 8, v7
    s_nop 1
    v_cndmask_b32 v8, v8, v9, vcc
    v_add_u32 v8, v8, v11
    buffer_load_dwordx4 v[144:147], v8, s[28:31], 0 offen
    v_and_b32 v13, 15, v2
    v_lshl_add_u32 v12, v13, 4, v12
    v_add_u32 v12, s20, v12
    s_waitcnt vmcnt(0)
    ds_write_b128 v12, v[144:147]

    v_add_u32 v7, 36, v10
    v_mul_u32_u24 v12, 272, v7
    v_min_u32 v7, 39, v7
    v_subrev_u32 v8, 8, v7
    v_add_u32 v8, s21, v8
    v_lshlrev_b32 v8, 13, v8
    v_add_u32 v8, 37748736, v8
    v_lshlrev_b32 v9, 13, v7
    v_add_u32 v9, s24, v9
    v_cmp_gt_u32 vcc, 8, v7
    s_nop 1
    v_cndmask_b32 v8, v8, v9, vcc
    v_add_u32 v8, v8, v11
    buffer_load_dwordx4 v[144:147], v8, s[28:31], 0 offen
    v_and_b32 v13, 15, v2
    v_lshl_add_u32 v12, v13, 4, v12
    v_add_u32 v12, s20, v12
    s_waitcnt vmcnt(0)
    ds_write_b128 v12, v[144:147]

    v_add_u32 v7, 40, v10
    v_mul_u32_u24 v12, 272, v7
    v_min_u32 v7, 39, v7
    v_subrev_u32 v8, 8, v7
    v_add_u32 v8, s21, v8
    v_lshlrev_b32 v8, 13, v8
    v_add_u32 v8, 37748736, v8
    v_lshlrev_b32 v9, 13, v7
    v_add_u32 v9, s24, v9
    v_cmp_gt_u32 vcc, 8, v7
    s_nop 1
    v_cndmask_b32 v8, v8, v9, vcc
    v_add_u32 v8, v8, v11
    buffer_load_dwordx4 v[144:147], v8, s[28:31], 0 offen
    v_and_b32 v13, 15, v2
    v_lshl_add_u32 v12, v13, 4, v12
    v_add_u32 v12, s20, v12
    s_waitcnt vmcnt(0)
    ds_write_b128 v12, v[144:147]

    v_add_u32 v7, 44, v10
    v_mul_u32_u24 v12, 272, v7
    v_min_u32 v7, 39, v7
    v_subrev_u32 v8, 8, v7
    v_add_u32 v8, s21, v8
    v_lshlrev_b32 v8, 13, v8
    v_add_u32 v8, 37748736, v8
    v_lshlrev_b32 v9, 13, v7
    v_add_u32 v9, s24, v9
    v_cmp_gt_u32 vcc, 8, v7
    s_nop 1
    v_cndmask_b32 v8, v8, v9, vcc
    v_add_u32 v8, v8, v11
    buffer_load_dwordx4 v[144:147], v8, s[28:31], 0 offen
    v_and_b32 v13, 15, v2
    v_lshl_add_u32 v12, v13, 4, v12
    v_add_u32 v12, s20, v12
    s_waitcnt vmcnt(0)
    ds_write_b128 v12, v[144:147]

    v_mov_b32 v96, 0
    v_mov_b32 v97, 0
    v_mov_b32 v98, 0
    v_mov_b32 v99, 0
    v_mov_b32 v100, 0
    v_mov_b32 v101, 0
    v_mov_b32 v102, 0
    v_mov_b32 v103, 0
    v_mov_b32 v104, 0
    v_mov_b32 v105, 0
    v_mov_b32 v106, 0
    v_mov_b32 v107, 0
    v_mov_b32 v108, 0
    v_mov_b32 v109, 0
    v_mov_b32 v110, 0
    v_mov_b32 v111, 0
    v_mov_b32 v112, 0
    v_mov_b32 v113, 0
    v_mov_b32 v114, 0
    v_mov_b32 v115, 0
    v_mov_b32 v116, 0
    v_mov_b32 v117, 0
    v_mov_b32 v118, 0
    v_mov_b32 v119, 0
    s_waitcnt vmcnt(0)
    s_nop 1
    v_mfma_f32_16x16x32_bf16 v[96:99], v[48:51], v[16:19], v[96:99]
    v_mfma_f32_16x16x32_bf16 v[100:103], v[48:51], v[32:35], v[100:103]
    v_mfma_f32_16x16x32_bf16 v[104:107], v[64:67], v[16:19], v[104:107]
    v_mfma_f32_16x16x32_bf16 v[108:111], v[64:67], v[32:35], v[108:111]
    v_mfma_f32_16x16x32_bf16 v[112:115], v[80:83], v[16:19], v[112:115]
    v_mfma_f32_16x16x32_bf16 v[116:119], v[80:83], v[32:35], v[116:119]
    v_mfma_f32_16x16x32_bf16 v[96:99], v[52:55], v[20:23], v[96:99]
    v_mfma_f32_16x16x32_bf16 v[100:103], v[52:55], v[36:39], v[100:103]
    v_mfma_f32_16x16x32_bf16 v[104:107], v[68:71], v[20:23], v[104:107]
    v_mfma_f32_16x16x32_bf16 v[108:111], v[68:71], v[36:39], v[108:111]
    v_mfma_f32_16x16x32_bf16 v[112:115], v[84:87], v[20:23], v[112:115]
    v_mfma_f32_16x16x32_bf16 v[116:119], v[84:87], v[36:39], v[116:119]
    v_mfma_f32_16x16x32_bf16 v[96:99], v[56:59], v[24:27], v[96:99]
    v_mfma_f32_16x16x32_bf16 v[100:103], v[56:59], v[40:43], v[100:103]
    v_mfma_f32_16x16x32_bf16 v[104:107], v[72:75], v[24:27], v[104:107]
    v_mfma_f32_16x16x32_bf16 v[108:111], v[72:75], v[40:43], v[108:111]
    v_mfma_f32_16x16x32_bf16 v[112:115], v[88:91], v[24:27], v[112:115]
    v_mfma_f32_16x16x32_bf16 v[116:119], v[88:91], v[40:43], v[116:119]
    v_mfma_f32_16x16x32_bf16 v[96:99], v[60:63], v[28:31], v[96:99]
    v_mfma_f32_16x16x32_bf16 v[100:103], v[60:63], v[44:47], v[100:103]
    v_mfma_f32_16x16x32_bf16 v[104:107], v[76:79], v[28:31], v[104:107]
    v_mfma_f32_16x16x32_bf16 v[108:111], v[76:79], v[44:47], v[108:111]
    v_mfma_f32_16x16x32_bf16 v[112:115], v[92:95], v[28:31], v[112:115]
    v_mfma_f32_16x16x32_bf16 v[116:119], v[92:95], v[44:47], v[116:119]
    s_nop 7
    s_nop 3
    s_mov_b32 s25, 0x3db504f3
    s_mov_b32 s26, 0xce6e6b28
    s_mov_b32 s27, 0x3fb8aa3b

    v_add_u32 v208, 8, v3
    v_lshlrev_b32 v209, 2, v4
    v_mov_b32 v210, 0xff800000

    v_cvt_pk_bf16_f32 v212, v96, v97
    v_cvt_pk_bf16_f32 v213, v98, v99
    v_lshlrev_b32 v96, 16, v212
    v_and_b32 v97, 0xffff0000, v212
    v_lshlrev_b32 v98, 16, v213
    v_and_b32 v99, 0xffff0000, v213

    v_mul_f32 v96, s25, v96
    v_mul_f32 v97, s25, v97
    v_mul_f32 v98, s25, v98
    v_mul_f32 v99, s25, v99
    v_cvt_pk_bf16_f32 v212, v96, v97
    v_cvt_pk_bf16_f32 v213, v98, v99
    v_lshlrev_b32 v96, 16, v212
    v_and_b32 v97, 0xffff0000, v212
    v_lshlrev_b32 v98, 16, v213
    v_and_b32 v99, 0xffff0000, v213

    v_add_u32 v211, 0, v209
    v_cmp_le_u32 vcc, v211, v208
    v_mov_b32 v212, s26
    s_nop 0
    v_cndmask_b32 v96, v212, v96, vcc
    v_max_f32 v210, v210, v96

    v_add_u32 v211, 1, v209
    v_cmp_le_u32 vcc, v211, v208
    v_mov_b32 v212, s26
    s_nop 0
    v_cndmask_b32 v97, v212, v97, vcc
    v_max_f32 v210, v210, v97

    v_add_u32 v211, 2, v209
    v_cmp_le_u32 vcc, v211, v208
    v_mov_b32 v212, s26
    s_nop 0
    v_cndmask_b32 v98, v212, v98, vcc
    v_max_f32 v210, v210, v98

    v_add_u32 v211, 3, v209
    v_cmp_le_u32 vcc, v211, v208
    v_mov_b32 v212, s26
    s_nop 0
    v_cndmask_b32 v99, v212, v99, vcc
    v_max_f32 v210, v210, v99

    v_cvt_pk_bf16_f32 v212, v104, v105
    v_cvt_pk_bf16_f32 v213, v106, v107
    v_lshlrev_b32 v104, 16, v212
    v_and_b32 v105, 0xffff0000, v212
    v_lshlrev_b32 v106, 16, v213
    v_and_b32 v107, 0xffff0000, v213

    v_mul_f32 v104, s25, v104
    v_mul_f32 v105, s25, v105
    v_mul_f32 v106, s25, v106
    v_mul_f32 v107, s25, v107
    v_cvt_pk_bf16_f32 v212, v104, v105
    v_cvt_pk_bf16_f32 v213, v106, v107
    v_lshlrev_b32 v104, 16, v212
    v_and_b32 v105, 0xffff0000, v212
    v_lshlrev_b32 v106, 16, v213
    v_and_b32 v107, 0xffff0000, v213

    v_add_u32 v211, 16, v209
    v_cmp_le_u32 vcc, v211, v208
    v_mov_b32 v212, s26
    s_nop 0
    v_cndmask_b32 v104, v212, v104, vcc
    v_max_f32 v210, v210, v104

    v_add_u32 v211, 17, v209
    v_cmp_le_u32 vcc, v211, v208
    v_mov_b32 v212, s26
    s_nop 0
    v_cndmask_b32 v105, v212, v105, vcc
    v_max_f32 v210, v210, v105

    v_add_u32 v211, 18, v209
    v_cmp_le_u32 vcc, v211, v208
    v_mov_b32 v212, s26
    s_nop 0
    v_cndmask_b32 v106, v212, v106, vcc
    v_max_f32 v210, v210, v106

    v_add_u32 v211, 19, v209
    v_cmp_le_u32 vcc, v211, v208
    v_mov_b32 v212, s26
    s_nop 0
    v_cndmask_b32 v107, v212, v107, vcc
    v_max_f32 v210, v210, v107

    v_cvt_pk_bf16_f32 v212, v112, v113
    v_cvt_pk_bf16_f32 v213, v114, v115
    v_lshlrev_b32 v112, 16, v212
    v_and_b32 v113, 0xffff0000, v212
    v_lshlrev_b32 v114, 16, v213
    v_and_b32 v115, 0xffff0000, v213

    v_mul_f32 v112, s25, v112
    v_mul_f32 v113, s25, v113
    v_mul_f32 v114, s25, v114
    v_mul_f32 v115, s25, v115
    v_cvt_pk_bf16_f32 v212, v112, v113
    v_cvt_pk_bf16_f32 v213, v114, v115
    v_lshlrev_b32 v112, 16, v212
    v_and_b32 v113, 0xffff0000, v212
    v_lshlrev_b32 v114, 16, v213
    v_and_b32 v115, 0xffff0000, v213

    v_add_u32 v211, 32, v209
    v_cmp_le_u32 vcc, v211, v208
    v_mov_b32 v212, s26
    s_nop 0
    v_cndmask_b32 v112, v212, v112, vcc
    v_max_f32 v210, v210, v112

    v_add_u32 v211, 33, v209
    v_cmp_le_u32 vcc, v211, v208
    v_mov_b32 v212, s26
    s_nop 0
    v_cndmask_b32 v113, v212, v113, vcc
    v_max_f32 v210, v210, v113

    v_add_u32 v211, 34, v209
    v_cmp_le_u32 vcc, v211, v208
    v_mov_b32 v212, s26
    s_nop 0
    v_cndmask_b32 v114, v212, v114, vcc
    v_max_f32 v210, v210, v114

    v_add_u32 v211, 35, v209
    v_cmp_le_u32 vcc, v211, v208
    v_mov_b32 v212, s26
    s_nop 0
    v_cndmask_b32 v115, v212, v115, vcc
    v_max_f32 v210, v210, v115

    v_xor_b32 v211, 16, v2
    v_lshlrev_b32 v211, 2, v211
    ds_bpermute_b32 v212, v211, v210
    s_waitcnt lgkmcnt(0)
    v_max_f32 v210, v210, v212
    v_xor_b32 v211, 32, v2
    v_lshlrev_b32 v211, 2, v211
    ds_bpermute_b32 v212, v211, v210
    s_waitcnt lgkmcnt(0)
    v_max_f32 v210, v210, v212
    v_mov_b32 v209, 0

    v_sub_f32 v96, v96, v210
    v_mul_f32 v96, s27, v96
    v_exp_f32 v96, v96
    s_nop 0
    v_add_f32 v209, v209, v96

    v_sub_f32 v97, v97, v210
    v_mul_f32 v97, s27, v97
    v_exp_f32 v97, v97
    s_nop 0
    v_add_f32 v209, v209, v97

    v_sub_f32 v98, v98, v210
    v_mul_f32 v98, s27, v98
    v_exp_f32 v98, v98
    s_nop 0
    v_add_f32 v209, v209, v98

    v_sub_f32 v99, v99, v210
    v_mul_f32 v99, s27, v99
    v_exp_f32 v99, v99
    s_nop 0
    v_add_f32 v209, v209, v99

    v_sub_f32 v104, v104, v210
    v_mul_f32 v104, s27, v104
    v_exp_f32 v104, v104
    s_nop 0
    v_add_f32 v209, v209, v104

    v_sub_f32 v105, v105, v210
    v_mul_f32 v105, s27, v105
    v_exp_f32 v105, v105
    s_nop 0
    v_add_f32 v209, v209, v105

    v_sub_f32 v106, v106, v210
    v_mul_f32 v106, s27, v106
    v_exp_f32 v106, v106
    s_nop 0
    v_add_f32 v209, v209, v106

    v_sub_f32 v107, v107, v210
    v_mul_f32 v107, s27, v107
    v_exp_f32 v107, v107
    s_nop 0
    v_add_f32 v209, v209, v107

    v_sub_f32 v112, v112, v210
    v_mul_f32 v112, s27, v112
    v_exp_f32 v112, v112
    s_nop 0
    v_add_f32 v209, v209, v112

    v_sub_f32 v113, v113, v210
    v_mul_f32 v113, s27, v113
    v_exp_f32 v113, v113
    s_nop 0
    v_add_f32 v209, v209, v113

    v_sub_f32 v114, v114, v210
    v_mul_f32 v114, s27, v114
    v_exp_f32 v114, v114
    s_nop 0
    v_add_f32 v209, v209, v114

    v_sub_f32 v115, v115, v210
    v_mul_f32 v115, s27, v115
    v_exp_f32 v115, v115
    s_nop 0
    v_add_f32 v209, v209, v115

    v_xor_b32 v211, 16, v2
    v_lshlrev_b32 v211, 2, v211
    ds_bpermute_b32 v212, v211, v209
    s_waitcnt lgkmcnt(0)
    v_add_f32 v209, v209, v212
    v_xor_b32 v211, 32, v2
    v_lshlrev_b32 v211, 2, v211
    ds_bpermute_b32 v212, v211, v209
    s_waitcnt lgkmcnt(0)
    v_add_f32 v209, v209, v212
    v_rcp_f32 v209, v209
    s_nop 0

    v_mul_f32 v96, v96, v209
    v_mul_f32 v97, v97, v209
    v_mul_f32 v98, v98, v209
    v_mul_f32 v99, v99, v209
    v_mul_f32 v104, v104, v209
    v_mul_f32 v105, v105, v209
    v_mul_f32 v106, v106, v209
    v_mul_f32 v107, v107, v209
    v_mul_f32 v112, v112, v209
    v_mul_f32 v113, v113, v209
    v_mul_f32 v114, v114, v209
    v_mul_f32 v115, v115, v209
    v_cvt_pk_bf16_f32 v120, v96, v97
    v_cvt_pk_bf16_f32 v121, v98, v99
    v_cvt_pk_bf16_f32 v122, v104, v105
    v_cvt_pk_bf16_f32 v123, v106, v107
    v_cvt_pk_bf16_f32 v124, v112, v113
    v_cvt_pk_bf16_f32 v125, v114, v115
    v_mov_b32 v126, 0
    v_mov_b32 v127, 0

    v_add_u32 v208, 24, v3
    v_lshlrev_b32 v209, 2, v4
    v_mov_b32 v210, 0xff800000

    v_cvt_pk_bf16_f32 v212, v100, v101
    v_cvt_pk_bf16_f32 v213, v102, v103
    v_lshlrev_b32 v100, 16, v212
    v_and_b32 v101, 0xffff0000, v212
    v_lshlrev_b32 v102, 16, v213
    v_and_b32 v103, 0xffff0000, v213

    v_mul_f32 v100, s25, v100
    v_mul_f32 v101, s25, v101
    v_mul_f32 v102, s25, v102
    v_mul_f32 v103, s25, v103
    v_cvt_pk_bf16_f32 v212, v100, v101
    v_cvt_pk_bf16_f32 v213, v102, v103
    v_lshlrev_b32 v100, 16, v212
    v_and_b32 v101, 0xffff0000, v212
    v_lshlrev_b32 v102, 16, v213
    v_and_b32 v103, 0xffff0000, v213

    v_add_u32 v211, 0, v209
    v_cmp_le_u32 vcc, v211, v208
    v_mov_b32 v212, s26
    s_nop 0
    v_cndmask_b32 v100, v212, v100, vcc
    v_max_f32 v210, v210, v100

    v_add_u32 v211, 1, v209
    v_cmp_le_u32 vcc, v211, v208
    v_mov_b32 v212, s26
    s_nop 0
    v_cndmask_b32 v101, v212, v101, vcc
    v_max_f32 v210, v210, v101

    v_add_u32 v211, 2, v209
    v_cmp_le_u32 vcc, v211, v208
    v_mov_b32 v212, s26
    s_nop 0
    v_cndmask_b32 v102, v212, v102, vcc
    v_max_f32 v210, v210, v102

    v_add_u32 v211, 3, v209
    v_cmp_le_u32 vcc, v211, v208
    v_mov_b32 v212, s26
    s_nop 0
    v_cndmask_b32 v103, v212, v103, vcc
    v_max_f32 v210, v210, v103

    v_cvt_pk_bf16_f32 v212, v108, v109
    v_cvt_pk_bf16_f32 v213, v110, v111
    v_lshlrev_b32 v108, 16, v212
    v_and_b32 v109, 0xffff0000, v212
    v_lshlrev_b32 v110, 16, v213
    v_and_b32 v111, 0xffff0000, v213

    v_mul_f32 v108, s25, v108
    v_mul_f32 v109, s25, v109
    v_mul_f32 v110, s25, v110
    v_mul_f32 v111, s25, v111
    v_cvt_pk_bf16_f32 v212, v108, v109
    v_cvt_pk_bf16_f32 v213, v110, v111
    v_lshlrev_b32 v108, 16, v212
    v_and_b32 v109, 0xffff0000, v212
    v_lshlrev_b32 v110, 16, v213
    v_and_b32 v111, 0xffff0000, v213

    v_add_u32 v211, 16, v209
    v_cmp_le_u32 vcc, v211, v208
    v_mov_b32 v212, s26
    s_nop 0
    v_cndmask_b32 v108, v212, v108, vcc
    v_max_f32 v210, v210, v108

    v_add_u32 v211, 17, v209
    v_cmp_le_u32 vcc, v211, v208
    v_mov_b32 v212, s26
    s_nop 0
    v_cndmask_b32 v109, v212, v109, vcc
    v_max_f32 v210, v210, v109

    v_add_u32 v211, 18, v209
    v_cmp_le_u32 vcc, v211, v208
    v_mov_b32 v212, s26
    s_nop 0
    v_cndmask_b32 v110, v212, v110, vcc
    v_max_f32 v210, v210, v110

    v_add_u32 v211, 19, v209
    v_cmp_le_u32 vcc, v211, v208
    v_mov_b32 v212, s26
    s_nop 0
    v_cndmask_b32 v111, v212, v111, vcc
    v_max_f32 v210, v210, v111

    v_cvt_pk_bf16_f32 v212, v116, v117
    v_cvt_pk_bf16_f32 v213, v118, v119
    v_lshlrev_b32 v116, 16, v212
    v_and_b32 v117, 0xffff0000, v212
    v_lshlrev_b32 v118, 16, v213
    v_and_b32 v119, 0xffff0000, v213

    v_mul_f32 v116, s25, v116
    v_mul_f32 v117, s25, v117
    v_mul_f32 v118, s25, v118
    v_mul_f32 v119, s25, v119
    v_cvt_pk_bf16_f32 v212, v116, v117
    v_cvt_pk_bf16_f32 v213, v118, v119
    v_lshlrev_b32 v116, 16, v212
    v_and_b32 v117, 0xffff0000, v212
    v_lshlrev_b32 v118, 16, v213
    v_and_b32 v119, 0xffff0000, v213

    v_add_u32 v211, 32, v209
    v_cmp_le_u32 vcc, v211, v208
    v_mov_b32 v212, s26
    s_nop 0
    v_cndmask_b32 v116, v212, v116, vcc
    v_max_f32 v210, v210, v116

    v_add_u32 v211, 33, v209
    v_cmp_le_u32 vcc, v211, v208
    v_mov_b32 v212, s26
    s_nop 0
    v_cndmask_b32 v117, v212, v117, vcc
    v_max_f32 v210, v210, v117

    v_add_u32 v211, 34, v209
    v_cmp_le_u32 vcc, v211, v208
    v_mov_b32 v212, s26
    s_nop 0
    v_cndmask_b32 v118, v212, v118, vcc
    v_max_f32 v210, v210, v118

    v_add_u32 v211, 35, v209
    v_cmp_le_u32 vcc, v211, v208
    v_mov_b32 v212, s26
    s_nop 0
    v_cndmask_b32 v119, v212, v119, vcc
    v_max_f32 v210, v210, v119

    v_xor_b32 v211, 16, v2
    v_lshlrev_b32 v211, 2, v211
    ds_bpermute_b32 v212, v211, v210
    s_waitcnt lgkmcnt(0)
    v_max_f32 v210, v210, v212
    v_xor_b32 v211, 32, v2
    v_lshlrev_b32 v211, 2, v211
    ds_bpermute_b32 v212, v211, v210
    s_waitcnt lgkmcnt(0)
    v_max_f32 v210, v210, v212
    v_mov_b32 v209, 0

    v_sub_f32 v100, v100, v210
    v_mul_f32 v100, s27, v100
    v_exp_f32 v100, v100
    s_nop 0
    v_add_f32 v209, v209, v100

    v_sub_f32 v101, v101, v210
    v_mul_f32 v101, s27, v101
    v_exp_f32 v101, v101
    s_nop 0
    v_add_f32 v209, v209, v101

    v_sub_f32 v102, v102, v210
    v_mul_f32 v102, s27, v102
    v_exp_f32 v102, v102
    s_nop 0
    v_add_f32 v209, v209, v102

    v_sub_f32 v103, v103, v210
    v_mul_f32 v103, s27, v103
    v_exp_f32 v103, v103
    s_nop 0
    v_add_f32 v209, v209, v103

    v_sub_f32 v108, v108, v210
    v_mul_f32 v108, s27, v108
    v_exp_f32 v108, v108
    s_nop 0
    v_add_f32 v209, v209, v108

    v_sub_f32 v109, v109, v210
    v_mul_f32 v109, s27, v109
    v_exp_f32 v109, v109
    s_nop 0
    v_add_f32 v209, v209, v109

    v_sub_f32 v110, v110, v210
    v_mul_f32 v110, s27, v110
    v_exp_f32 v110, v110
    s_nop 0
    v_add_f32 v209, v209, v110

    v_sub_f32 v111, v111, v210
    v_mul_f32 v111, s27, v111
    v_exp_f32 v111, v111
    s_nop 0
    v_add_f32 v209, v209, v111

    v_sub_f32 v116, v116, v210
    v_mul_f32 v116, s27, v116
    v_exp_f32 v116, v116
    s_nop 0
    v_add_f32 v209, v209, v116

    v_sub_f32 v117, v117, v210
    v_mul_f32 v117, s27, v117
    v_exp_f32 v117, v117
    s_nop 0
    v_add_f32 v209, v209, v117

    v_sub_f32 v118, v118, v210
    v_mul_f32 v118, s27, v118
    v_exp_f32 v118, v118
    s_nop 0
    v_add_f32 v209, v209, v118

    v_sub_f32 v119, v119, v210
    v_mul_f32 v119, s27, v119
    v_exp_f32 v119, v119
    s_nop 0
    v_add_f32 v209, v209, v119

    v_xor_b32 v211, 16, v2
    v_lshlrev_b32 v211, 2, v211
    ds_bpermute_b32 v212, v211, v209
    s_waitcnt lgkmcnt(0)
    v_add_f32 v209, v209, v212
    v_xor_b32 v211, 32, v2
    v_lshlrev_b32 v211, 2, v211
    ds_bpermute_b32 v212, v211, v209
    s_waitcnt lgkmcnt(0)
    v_add_f32 v209, v209, v212
    v_rcp_f32 v209, v209
    s_nop 0

    v_mul_f32 v100, v100, v209
    v_mul_f32 v101, v101, v209
    v_mul_f32 v102, v102, v209
    v_mul_f32 v103, v103, v209
    v_mul_f32 v108, v108, v209
    v_mul_f32 v109, v109, v209
    v_mul_f32 v110, v110, v209
    v_mul_f32 v111, v111, v209
    v_mul_f32 v116, v116, v209
    v_mul_f32 v117, v117, v209
    v_mul_f32 v118, v118, v209
    v_mul_f32 v119, v119, v209
    v_cvt_pk_bf16_f32 v128, v100, v101
    v_cvt_pk_bf16_f32 v129, v102, v103
    v_cvt_pk_bf16_f32 v130, v108, v109
    v_cvt_pk_bf16_f32 v131, v110, v111
    v_cvt_pk_bf16_f32 v132, v116, v117
    v_cvt_pk_bf16_f32 v133, v118, v119
    v_mov_b32 v134, 0
    v_mov_b32 v135, 0

    v_bfe_u32 v208, v2, 2, 2
    v_lshl_add_u32 v208, v4, 2, v208
    v_mul_u32_u24 v208, 272, v208
    v_and_b32 v209, 3, v2
    v_lshl_add_u32 v208, v209, 3, v208
    v_add_u32 v208, s20, v208
    v_mov_b32 v142, 0
    v_mov_b32 v143, 0
    s_waitcnt lgkmcnt(0)

    ds_read_b64_tr_b16 v[136:137], v208 offset:0
    ds_read_b64_tr_b16 v[138:139], v208 offset:4352
    ds_read_b64_tr_b16 v[140:141], v208 offset:8704

    v_mov_b32 v144, 0
    v_mov_b32 v145, 0
    v_mov_b32 v146, 0
    v_mov_b32 v147, 0
    v_mov_b32 v148, 0
    v_mov_b32 v149, 0
    v_mov_b32 v150, 0
    v_mov_b32 v151, 0
    s_waitcnt lgkmcnt(0)
    s_nop 1
    v_mfma_f32_16x16x32_bf16 v[144:147], v[136:139], v[120:123], v[144:147]
    v_mfma_f32_16x16x32_bf16 v[144:147], v[140:143], v[124:127], v[144:147]

    v_mfma_f32_16x16x32_bf16 v[148:151], v[136:139], v[128:131], v[148:151]
    v_mfma_f32_16x16x32_bf16 v[148:151], v[140:143], v[132:135], v[148:151]

    s_nop 7
    ds_read_b64_tr_b16 v[136:137], v208 offset:32
    ds_read_b64_tr_b16 v[138:139], v208 offset:4384
    ds_read_b64_tr_b16 v[140:141], v208 offset:8736

    v_mov_b32 v152, 0
    v_mov_b32 v153, 0
    v_mov_b32 v154, 0
    v_mov_b32 v155, 0
    v_mov_b32 v156, 0
    v_mov_b32 v157, 0
    v_mov_b32 v158, 0
    v_mov_b32 v159, 0
    s_waitcnt lgkmcnt(0)
    s_nop 1
    v_mfma_f32_16x16x32_bf16 v[152:155], v[136:139], v[120:123], v[152:155]
    v_mfma_f32_16x16x32_bf16 v[152:155], v[140:143], v[124:127], v[152:155]

    v_mfma_f32_16x16x32_bf16 v[156:159], v[136:139], v[128:131], v[156:159]
    v_mfma_f32_16x16x32_bf16 v[156:159], v[140:143], v[132:135], v[156:159]

    s_nop 7
    ds_read_b64_tr_b16 v[136:137], v208 offset:64
    ds_read_b64_tr_b16 v[138:139], v208 offset:4416
    ds_read_b64_tr_b16 v[140:141], v208 offset:8768

    v_mov_b32 v160, 0
    v_mov_b32 v161, 0
    v_mov_b32 v162, 0
    v_mov_b32 v163, 0
    v_mov_b32 v164, 0
    v_mov_b32 v165, 0
    v_mov_b32 v166, 0
    v_mov_b32 v167, 0
    s_waitcnt lgkmcnt(0)
    s_nop 1
    v_mfma_f32_16x16x32_bf16 v[160:163], v[136:139], v[120:123], v[160:163]
    v_mfma_f32_16x16x32_bf16 v[160:163], v[140:143], v[124:127], v[160:163]

    v_mfma_f32_16x16x32_bf16 v[164:167], v[136:139], v[128:131], v[164:167]
    v_mfma_f32_16x16x32_bf16 v[164:167], v[140:143], v[132:135], v[164:167]

    s_nop 7
    ds_read_b64_tr_b16 v[136:137], v208 offset:96
    ds_read_b64_tr_b16 v[138:139], v208 offset:4448
    ds_read_b64_tr_b16 v[140:141], v208 offset:8800

    v_mov_b32 v168, 0
    v_mov_b32 v169, 0
    v_mov_b32 v170, 0
    v_mov_b32 v171, 0
    v_mov_b32 v172, 0
    v_mov_b32 v173, 0
    v_mov_b32 v174, 0
    v_mov_b32 v175, 0
    s_waitcnt lgkmcnt(0)
    s_nop 1
    v_mfma_f32_16x16x32_bf16 v[168:171], v[136:139], v[120:123], v[168:171]
    v_mfma_f32_16x16x32_bf16 v[168:171], v[140:143], v[124:127], v[168:171]

    v_mfma_f32_16x16x32_bf16 v[172:175], v[136:139], v[128:131], v[172:175]
    v_mfma_f32_16x16x32_bf16 v[172:175], v[140:143], v[132:135], v[172:175]

    s_nop 7
    ds_read_b64_tr_b16 v[136:137], v208 offset:128
    ds_read_b64_tr_b16 v[138:139], v208 offset:4480
    ds_read_b64_tr_b16 v[140:141], v208 offset:8832

    v_mov_b32 v176, 0
    v_mov_b32 v177, 0
    v_mov_b32 v178, 0
    v_mov_b32 v179, 0
    v_mov_b32 v180, 0
    v_mov_b32 v181, 0
    v_mov_b32 v182, 0
    v_mov_b32 v183, 0
    s_waitcnt lgkmcnt(0)
    s_nop 1
    v_mfma_f32_16x16x32_bf16 v[176:179], v[136:139], v[120:123], v[176:179]
    v_mfma_f32_16x16x32_bf16 v[176:179], v[140:143], v[124:127], v[176:179]

    v_mfma_f32_16x16x32_bf16 v[180:183], v[136:139], v[128:131], v[180:183]
    v_mfma_f32_16x16x32_bf16 v[180:183], v[140:143], v[132:135], v[180:183]

    s_nop 7
    ds_read_b64_tr_b16 v[136:137], v208 offset:160
    ds_read_b64_tr_b16 v[138:139], v208 offset:4512
    ds_read_b64_tr_b16 v[140:141], v208 offset:8864

    v_mov_b32 v184, 0
    v_mov_b32 v185, 0
    v_mov_b32 v186, 0
    v_mov_b32 v187, 0
    v_mov_b32 v188, 0
    v_mov_b32 v189, 0
    v_mov_b32 v190, 0
    v_mov_b32 v191, 0
    s_waitcnt lgkmcnt(0)
    s_nop 1
    v_mfma_f32_16x16x32_bf16 v[184:187], v[136:139], v[120:123], v[184:187]
    v_mfma_f32_16x16x32_bf16 v[184:187], v[140:143], v[124:127], v[184:187]

    v_mfma_f32_16x16x32_bf16 v[188:191], v[136:139], v[128:131], v[188:191]
    v_mfma_f32_16x16x32_bf16 v[188:191], v[140:143], v[132:135], v[188:191]

    s_nop 7
    ds_read_b64_tr_b16 v[136:137], v208 offset:192
    ds_read_b64_tr_b16 v[138:139], v208 offset:4544
    ds_read_b64_tr_b16 v[140:141], v208 offset:8896

    v_mov_b32 v192, 0
    v_mov_b32 v193, 0
    v_mov_b32 v194, 0
    v_mov_b32 v195, 0
    v_mov_b32 v196, 0
    v_mov_b32 v197, 0
    v_mov_b32 v198, 0
    v_mov_b32 v199, 0
    s_waitcnt lgkmcnt(0)
    s_nop 1
    v_mfma_f32_16x16x32_bf16 v[192:195], v[136:139], v[120:123], v[192:195]
    v_mfma_f32_16x16x32_bf16 v[192:195], v[140:143], v[124:127], v[192:195]

    v_mfma_f32_16x16x32_bf16 v[196:199], v[136:139], v[128:131], v[196:199]
    v_mfma_f32_16x16x32_bf16 v[196:199], v[140:143], v[132:135], v[196:199]

    s_nop 7
    ds_read_b64_tr_b16 v[136:137], v208 offset:224
    ds_read_b64_tr_b16 v[138:139], v208 offset:4576
    ds_read_b64_tr_b16 v[140:141], v208 offset:8928

    v_mov_b32 v200, 0
    v_mov_b32 v201, 0
    v_mov_b32 v202, 0
    v_mov_b32 v203, 0
    v_mov_b32 v204, 0
    v_mov_b32 v205, 0
    v_mov_b32 v206, 0
    v_mov_b32 v207, 0
    s_waitcnt lgkmcnt(0)
    s_nop 1
    v_mfma_f32_16x16x32_bf16 v[200:203], v[136:139], v[120:123], v[200:203]
    v_mfma_f32_16x16x32_bf16 v[200:203], v[140:143], v[124:127], v[200:203]

    v_mfma_f32_16x16x32_bf16 v[204:207], v[136:139], v[128:131], v[204:207]
    v_mfma_f32_16x16x32_bf16 v[204:207], v[140:143], v[132:135], v[204:207]

    s_nop 7
    s_nop 7
    s_nop 3
    v_add_u32 v5, s21, v3
    v_lshlrev_b32 v5, 13, v5
    v_lshl_add_u32 v6, v4, 3, s22
    v_add_u32 v5, v5, v6
    v_add_u32 v5, 71303168, v5

    v_cvt_pk_bf16_f32 v208, v144, v145
    v_cvt_pk_bf16_f32 v209, v146, v147
    buffer_store_dwordx2 v[208:209], v5, s[28:31], 0 offen offset:0
    s_nop 1

    v_cvt_pk_bf16_f32 v208, v152, v153
    v_cvt_pk_bf16_f32 v209, v154, v155
    buffer_store_dwordx2 v[208:209], v5, s[28:31], 0 offen offset:32
    s_nop 1

    v_cvt_pk_bf16_f32 v208, v160, v161
    v_cvt_pk_bf16_f32 v209, v162, v163
    buffer_store_dwordx2 v[208:209], v5, s[28:31], 0 offen offset:64
    s_nop 1

    v_cvt_pk_bf16_f32 v208, v168, v169
    v_cvt_pk_bf16_f32 v209, v170, v171
    buffer_store_dwordx2 v[208:209], v5, s[28:31], 0 offen offset:96
    s_nop 1

    v_cvt_pk_bf16_f32 v208, v176, v177
    v_cvt_pk_bf16_f32 v209, v178, v179
    buffer_store_dwordx2 v[208:209], v5, s[28:31], 0 offen offset:128
    s_nop 1

    v_cvt_pk_bf16_f32 v208, v184, v185
    v_cvt_pk_bf16_f32 v209, v186, v187
    buffer_store_dwordx2 v[208:209], v5, s[28:31], 0 offen offset:160
    s_nop 1

    v_cvt_pk_bf16_f32 v208, v192, v193
    v_cvt_pk_bf16_f32 v209, v194, v195
    buffer_store_dwordx2 v[208:209], v5, s[28:31], 0 offen offset:192
    s_nop 1

    v_cvt_pk_bf16_f32 v208, v200, v201
    v_cvt_pk_bf16_f32 v209, v202, v203
    buffer_store_dwordx2 v[208:209], v5, s[28:31], 0 offen offset:224
    s_nop 1

    v_add_u32 v5, 131072, v5
    v_cvt_pk_bf16_f32 v208, v148, v149
    v_cvt_pk_bf16_f32 v209, v150, v151
    buffer_store_dwordx2 v[208:209], v5, s[28:31], 0 offen offset:0
    s_nop 1

    v_cvt_pk_bf16_f32 v208, v156, v157
    v_cvt_pk_bf16_f32 v209, v158, v159
    buffer_store_dwordx2 v[208:209], v5, s[28:31], 0 offen offset:32
    s_nop 1

    v_cvt_pk_bf16_f32 v208, v164, v165
    v_cvt_pk_bf16_f32 v209, v166, v167
    buffer_store_dwordx2 v[208:209], v5, s[28:31], 0 offen offset:64
    s_nop 1

    v_cvt_pk_bf16_f32 v208, v172, v173
    v_cvt_pk_bf16_f32 v209, v174, v175
    buffer_store_dwordx2 v[208:209], v5, s[28:31], 0 offen offset:96
    s_nop 1

    v_cvt_pk_bf16_f32 v208, v180, v181
    v_cvt_pk_bf16_f32 v209, v182, v183
    buffer_store_dwordx2 v[208:209], v5, s[28:31], 0 offen offset:128
    s_nop 1

    v_cvt_pk_bf16_f32 v208, v188, v189
    v_cvt_pk_bf16_f32 v209, v190, v191
    buffer_store_dwordx2 v[208:209], v5, s[28:31], 0 offen offset:160
    s_nop 1

    v_cvt_pk_bf16_f32 v208, v196, v197
    v_cvt_pk_bf16_f32 v209, v198, v199
    buffer_store_dwordx2 v[208:209], v5, s[28:31], 0 offen offset:192
    s_nop 1

    v_cvt_pk_bf16_f32 v208, v204, v205
    v_cvt_pk_bf16_f32 v209, v206, v207
    buffer_store_dwordx2 v[208:209], v5, s[28:31], 0 offen offset:224
    s_nop 1

K4_END:
    s_endpgm
.globl k5_gemm_kernel
.p2align 8
.type k5_gemm_kernel,@function
k5_gemm_kernel:
    s_cmp_ge_u32 s2, 256
    s_cbranch_scc1 K5_END
    s_load_dwordx2 s[4:5], s[0:1], 40
    s_load_dwordx2 s[6:7], s[0:1], 80
    s_load_dwordx2 s[12:13], s[0:1], 112
    s_load_dwordx2 s[14:15], s[0:1], 88
    s_and_b32 s16, s2, 15
    s_bfe_u32 s17, s2, 0x30004
    s_lshr_b32 s18, s2, 7
    s_waitcnt lgkmcnt(0)
    s_lshl_b32 s40, s16, 7
    s_lshl_b32 s41, s17, 8
    s_mov_b32 s43, 2048
    s_cmp_eq_u32 s18, 1
    s_mov_b32 s42, 8192
    s_cselect_b32 s42, 7168, s42
    s_mov_b32 s19, 71303168
    s_cselect_b32 s19, 54525952, s19
    s_mov_b32 s24, 16777216
    s_cselect_b32 s24, 14680064, s24
    s_mov_b32 s25, 8388608
    s_cselect_b32 s25, 7340032, s25
    s_cselect_b32 s26, s6, s4
    s_cselect_b32 s27, s7, s5
    s_mov_b32 s22, 4194304
    s_cselect_b32 s22, 20971520, s22
    s_add_u32 s20, s12, s19
    s_addc_u32 s21, s13, 0
    s_mov_b32 s28, s20
    s_and_b32 s29, s21, 0xffff
    s_mov_b32 s30, s24
    s_mov_b32 s31, 0x00020000
    s_mov_b32 s32, s26
    s_and_b32 s33, s27, 0xffff
    s_mov_b32 s34, s25
    s_mov_b32 s35, 0x00020000

    s_mov_b32 s64, s12
    s_and_b32 s65, s13, 0xffff
    s_mov_b32 s66, 268435456
    s_mov_b32 s67, 0x00020000

    s_mov_b32 s68, s14
    s_and_b32 s69, s15, 0xffff
    s_mov_b32 s70, 2048
    s_mov_b32 s71, 0x00020000

    v_lshrrev_b32 v9, 2, v0
    v_and_b32 v10, 3, v0
    v_add_u32 v11, s40, v9
    v_mul_lo_u32 v1, v11, s42
    v_lshl_add_u32 v1, v10, 4, v1
    s_lshl_b32 s44, s42, 6
    v_add_u32 v2, s44, v1
    v_mul_u32_u24 v5, 80, v9
    v_lshl_add_u32 v5, v10, 4, v5
    v_lshrrev_b32 v9, 4, v0
    v_and_b32 v10, 15, v0
    v_mul_lo_u32 v3, v9, s43
    v_lshl_add_u32 v3, v10, 4, v3
    v_add_u32 v3, s41, v3
    s_mul_i32 s44, s43, 16
    v_add_u32 v4, s44, v3
    v_mul_u32_u24 v6, 272, v9
    v_lshl_add_u32 v6, v10, 4, v6
    v_add_u32 v6, 10240, v6
    v_lshrrev_b32 v9, 6, v0
    v_and_b32 v10, 63, v0
    v_lshrrev_b32 v11, 1, v9
    v_and_b32 v12, 1, v9
    v_and_b32 v9, 15, v10
    v_lshl_add_u32 v9, v11, 6, v9
    v_mul_u32_u24 v7, 80, v9
    v_lshrrev_b32 v9, 4, v10
    v_lshl_add_u32 v7, v9, 4, v7
    v_lshlrev_b32 v9, 3, v9
    v_bfe_u32 v11, v10, 2, 2
    v_add_u32 v9, v9, v11
    v_mul_u32_u24 v8, 272, v9
    v_and_b32 v11, 3, v10
    v_lshl_add_u32 v8, v11, 3, v8
    v_mul_u32_u24 v12, 128, v12
    v_add_u32 v8, v8, v12
    v_add_u32 v8, 10240, v8

    v_mov_b32 v64, 0
    v_mov_b32 v65, 0
    v_mov_b32 v66, 0
    v_mov_b32 v67, 0
    v_mov_b32 v68, 0
    v_mov_b32 v69, 0
    v_mov_b32 v70, 0
    v_mov_b32 v71, 0
    v_mov_b32 v72, 0
    v_mov_b32 v73, 0
    v_mov_b32 v74, 0
    v_mov_b32 v75, 0
    v_mov_b32 v76, 0
    v_mov_b32 v77, 0
    v_mov_b32 v78, 0
    v_mov_b32 v79, 0
    v_mov_b32 v80, 0
    v_mov_b32 v81, 0
    v_mov_b32 v82, 0
    v_mov_b32 v83, 0
    v_mov_b32 v84, 0
    v_mov_b32 v85, 0
    v_mov_b32 v86, 0
    v_mov_b32 v87, 0
    v_mov_b32 v88, 0
    v_mov_b32 v89, 0
    v_mov_b32 v90, 0
    v_mov_b32 v91, 0
    v_mov_b32 v92, 0
    v_mov_b32 v93, 0
    v_mov_b32 v94, 0
    v_mov_b32 v95, 0
    v_mov_b32 v96, 0
    v_mov_b32 v97, 0
    v_mov_b32 v98, 0
    v_mov_b32 v99, 0
    v_mov_b32 v100, 0
    v_mov_b32 v101, 0
    v_mov_b32 v102, 0
    v_mov_b32 v103, 0
    v_mov_b32 v104, 0
    v_mov_b32 v105, 0
    v_mov_b32 v106, 0
    v_mov_b32 v107, 0
    v_mov_b32 v108, 0
    v_mov_b32 v109, 0
    v_mov_b32 v110, 0
    v_mov_b32 v111, 0
    v_mov_b32 v112, 0
    v_mov_b32 v113, 0
    v_mov_b32 v114, 0
    v_mov_b32 v115, 0
    v_mov_b32 v116, 0
    v_mov_b32 v117, 0
    v_mov_b32 v118, 0
    v_mov_b32 v119, 0
    v_mov_b32 v120, 0
    v_mov_b32 v121, 0
    v_mov_b32 v122, 0
    v_mov_b32 v123, 0
    v_mov_b32 v124, 0
    v_mov_b32 v125, 0
    v_mov_b32 v126, 0
    v_mov_b32 v127, 0
    s_mov_b32 s45, 0
    s_mov_b32 s46, 0
    s_mov_b32 s47, 0
    s_mov_b32 s48, 20480
    s_lshl_b32 s50, s43, 5
    s_mov_b32 s49, 128

    buffer_load_dwordx4 v[16:19], v1, s[28:31], s45 offen
    buffer_load_dwordx4 v[20:23], v2, s[28:31], s45 offen
    buffer_load_dwordx4 v[24:27], v3, s[32:35], s46 offen

    buffer_load_dwordx4 v[28:31], v4, s[32:35], s46 offen
    s_waitcnt vmcnt(0)
    v_add_u32 v9, s47, v5
    v_add_u32 v10, s47, v6
    ds_write_b128 v9, v[16:19]
    ds_write_b128 v9, v[20:23] offset:5120
    ds_write_b128 v10, v[24:27]

    ds_write_b128 v10, v[28:31] offset:4352
    s_waitcnt lgkmcnt(0)
    s_barrier
    s_mov_b32 s47, 20480
    s_mov_b32 s48, 0

GL_10:
    s_add_u32 s45, s45, 64
    s_add_u32 s46, s46, s50
    s_sub_u32 s49, s49, 1

    buffer_load_dwordx4 v[16:19], v1, s[28:31], s45 offen
    buffer_load_dwordx4 v[20:23], v2, s[28:31], s45 offen
    buffer_load_dwordx4 v[24:27], v3, s[32:35], s46 offen

    buffer_load_dwordx4 v[28:31], v4, s[32:35], s46 offen
    v_add_u32 v11, s48, v7
    v_add_u32 v12, s48, v8

    ds_read_b128 v[48:51], v11 offset:0
    ds_read_b128 v[52:55], v11 offset:1280
    ds_read_b128 v[56:59], v11 offset:2560
    ds_read_b128 v[60:63], v11 offset:3840
    ds_read_b64_tr_b16 v[32:33], v12 offset:0
    ds_read_b64_tr_b16 v[34:35], v12 offset:1088

    ds_read_b64_tr_b16 v[36:37], v12 offset:32
    ds_read_b64_tr_b16 v[38:39], v12 offset:1120

    ds_read_b64_tr_b16 v[40:41], v12 offset:64
    ds_read_b64_tr_b16 v[42:43], v12 offset:1152

    ds_read_b64_tr_b16 v[44:45], v12 offset:96
    ds_read_b64_tr_b16 v[46:47], v12 offset:1184

    s_waitcnt lgkmcnt(0)
    v_mfma_f32_16x16x32_bf16 v[64:67], v[32:35], v[48:51], v[64:67]
    v_mfma_f32_16x16x32_bf16 v[68:71], v[32:35], v[52:55], v[68:71]
    v_mfma_f32_16x16x32_bf16 v[72:75], v[32:35], v[56:59], v[72:75]
    v_mfma_f32_16x16x32_bf16 v[76:79], v[32:35], v[60:63], v[76:79]
    v_mfma_f32_16x16x32_bf16 v[80:83], v[36:39], v[48:51], v[80:83]
    v_mfma_f32_16x16x32_bf16 v[84:87], v[36:39], v[52:55], v[84:87]
    v_mfma_f32_16x16x32_bf16 v[88:91], v[36:39], v[56:59], v[88:91]
    v_mfma_f32_16x16x32_bf16 v[92:95], v[36:39], v[60:63], v[92:95]
    v_mfma_f32_16x16x32_bf16 v[96:99], v[40:43], v[48:51], v[96:99]
    v_mfma_f32_16x16x32_bf16 v[100:103], v[40:43], v[52:55], v[100:103]
    v_mfma_f32_16x16x32_bf16 v[104:107], v[40:43], v[56:59], v[104:107]
    v_mfma_f32_16x16x32_bf16 v[108:111], v[40:43], v[60:63], v[108:111]
    v_mfma_f32_16x16x32_bf16 v[112:115], v[44:47], v[48:51], v[112:115]
    v_mfma_f32_16x16x32_bf16 v[116:119], v[44:47], v[52:55], v[116:119]
    v_mfma_f32_16x16x32_bf16 v[120:123], v[44:47], v[56:59], v[120:123]
    v_mfma_f32_16x16x32_bf16 v[124:127], v[44:47], v[60:63], v[124:127]
    s_waitcnt vmcnt(0)
    v_add_u32 v9, s47, v5
    v_add_u32 v10, s47, v6
    ds_write_b128 v9, v[16:19]
    ds_write_b128 v9, v[20:23] offset:5120
    ds_write_b128 v10, v[24:27]

    ds_write_b128 v10, v[28:31] offset:4352
    s_waitcnt lgkmcnt(0)
    s_barrier
    s_xor_b32 s47, s47, 20480
    s_xor_b32 s48, s48, 20480
    s_cmp_gt_u32 s49, 0
    s_cbranch_scc1 GL_10

    s_nop 7
    s_nop 7
    v_lshrrev_b32 v9, 6, v0
    v_and_b32 v10, 63, v0
    v_lshrrev_b32 v11, 1, v9
    v_and_b32 v12, 1, v9
    v_and_b32 v1, 15, v10
    v_lshl_add_u32 v1, v11, 6, v1
    v_add_u32 v1, s40, v1
    v_lshlrev_b32 v1, 11, v1
    v_lshrrev_b32 v2, 4, v10
    v_lshlrev_b32 v2, 3, v2
    v_lshl_add_u32 v2, v12, 7, v2
    v_add_u32 v2, s41, v2
    v_add_u32 v1, v1, v2
    v_add_u32 v1, s22, v1

    buffer_load_dwordx2 v[16:17], v2, s[68:71], 0 offen offset:0
    buffer_load_dwordx2 v[18:19], v2, s[68:71], 0 offen offset:32
    buffer_load_dwordx2 v[20:21], v2, s[68:71], 0 offen offset:64
    buffer_load_dwordx2 v[22:23], v2, s[68:71], 0 offen offset:96
    s_waitcnt vmcnt(0)
    v_lshlrev_b32 v24, 16, v16
    v_and_b32 v25, 0xffff0000, v16
    v_lshlrev_b32 v26, 16, v17
    v_and_b32 v27, 0xffff0000, v17

    v_lshlrev_b32 v28, 16, v18
    v_and_b32 v29, 0xffff0000, v18
    v_lshlrev_b32 v30, 16, v19
    v_and_b32 v31, 0xffff0000, v19

    v_lshlrev_b32 v32, 16, v20
    v_and_b32 v33, 0xffff0000, v20
    v_lshlrev_b32 v34, 16, v21
    v_and_b32 v35, 0xffff0000, v21

    v_lshlrev_b32 v36, 16, v22
    v_and_b32 v37, 0xffff0000, v22
    v_lshlrev_b32 v38, 16, v23
    v_and_b32 v39, 0xffff0000, v23

    v_cvt_f32_u32 v15, s18
    v_mul_f32 v24, v24, v15
    v_mul_f32 v25, v25, v15
    v_mul_f32 v26, v26, v15
    v_mul_f32 v27, v27, v15
    v_mul_f32 v28, v28, v15
    v_mul_f32 v29, v29, v15
    v_mul_f32 v30, v30, v15
    v_mul_f32 v31, v31, v15
    v_mul_f32 v32, v32, v15
    v_mul_f32 v33, v33, v15
    v_mul_f32 v34, v34, v15
    v_mul_f32 v35, v35, v15
    v_mul_f32 v36, v36, v15
    v_mul_f32 v37, v37, v15
    v_mul_f32 v38, v38, v15
    v_mul_f32 v39, v39, v15
    v_cvt_pk_bf16_f32 v9, v64, v65
    v_cvt_pk_bf16_f32 v10, v66, v67
    v_lshlrev_b32 v40, 16, v9
    v_and_b32 v41, 0xffff0000, v9
    v_lshlrev_b32 v42, 16, v10
    v_and_b32 v43, 0xffff0000, v10
    v_add_f32 v40, v40, v24
    v_add_f32 v41, v41, v25
    v_add_f32 v42, v42, v26
    v_add_f32 v43, v43, v27
    v_cvt_pk_bf16_f32 v16, v40, v41
    v_cvt_pk_bf16_f32 v17, v42, v43

    v_cvt_pk_bf16_f32 v9, v80, v81
    v_cvt_pk_bf16_f32 v10, v82, v83
    v_lshlrev_b32 v40, 16, v9
    v_and_b32 v41, 0xffff0000, v9
    v_lshlrev_b32 v42, 16, v10
    v_and_b32 v43, 0xffff0000, v10
    v_add_f32 v40, v40, v28
    v_add_f32 v41, v41, v29
    v_add_f32 v42, v42, v30
    v_add_f32 v43, v43, v31
    v_cvt_pk_bf16_f32 v18, v40, v41
    v_cvt_pk_bf16_f32 v19, v42, v43

    v_cvt_pk_bf16_f32 v9, v96, v97
    v_cvt_pk_bf16_f32 v10, v98, v99
    v_lshlrev_b32 v40, 16, v9
    v_and_b32 v41, 0xffff0000, v9
    v_lshlrev_b32 v42, 16, v10
    v_and_b32 v43, 0xffff0000, v10
    v_add_f32 v40, v40, v32
    v_add_f32 v41, v41, v33
    v_add_f32 v42, v42, v34
    v_add_f32 v43, v43, v35
    v_cvt_pk_bf16_f32 v20, v40, v41
    v_cvt_pk_bf16_f32 v21, v42, v43

    v_cvt_pk_bf16_f32 v9, v112, v113
    v_cvt_pk_bf16_f32 v10, v114, v115
    v_lshlrev_b32 v40, 16, v9
    v_and_b32 v41, 0xffff0000, v9
    v_lshlrev_b32 v42, 16, v10
    v_and_b32 v43, 0xffff0000, v10
    v_add_f32 v40, v40, v36
    v_add_f32 v41, v41, v37
    v_add_f32 v42, v42, v38
    v_add_f32 v43, v43, v39
    v_cvt_pk_bf16_f32 v22, v40, v41
    v_cvt_pk_bf16_f32 v23, v42, v43

    buffer_store_dwordx2 v[16:17], v1, s[64:67], 0 offen offset:0
    buffer_store_dwordx2 v[18:19], v1, s[64:67], 0 offen offset:32
    buffer_store_dwordx2 v[20:21], v1, s[64:67], 0 offen offset:64
    buffer_store_dwordx2 v[22:23], v1, s[64:67], 0 offen offset:96
    v_add_u32 v1, 32768, v1
    s_nop 1
    v_cvt_pk_bf16_f32 v9, v68, v69
    v_cvt_pk_bf16_f32 v10, v70, v71
    v_lshlrev_b32 v40, 16, v9
    v_and_b32 v41, 0xffff0000, v9
    v_lshlrev_b32 v42, 16, v10
    v_and_b32 v43, 0xffff0000, v10
    v_add_f32 v40, v40, v24
    v_add_f32 v41, v41, v25
    v_add_f32 v42, v42, v26
    v_add_f32 v43, v43, v27
    v_cvt_pk_bf16_f32 v16, v40, v41
    v_cvt_pk_bf16_f32 v17, v42, v43

    v_cvt_pk_bf16_f32 v9, v84, v85
    v_cvt_pk_bf16_f32 v10, v86, v87
    v_lshlrev_b32 v40, 16, v9
    v_and_b32 v41, 0xffff0000, v9
    v_lshlrev_b32 v42, 16, v10
    v_and_b32 v43, 0xffff0000, v10
    v_add_f32 v40, v40, v28
    v_add_f32 v41, v41, v29
    v_add_f32 v42, v42, v30
    v_add_f32 v43, v43, v31
    v_cvt_pk_bf16_f32 v18, v40, v41
    v_cvt_pk_bf16_f32 v19, v42, v43

    v_cvt_pk_bf16_f32 v9, v100, v101
    v_cvt_pk_bf16_f32 v10, v102, v103
    v_lshlrev_b32 v40, 16, v9
    v_and_b32 v41, 0xffff0000, v9
    v_lshlrev_b32 v42, 16, v10
    v_and_b32 v43, 0xffff0000, v10
    v_add_f32 v40, v40, v32
    v_add_f32 v41, v41, v33
    v_add_f32 v42, v42, v34
    v_add_f32 v43, v43, v35
    v_cvt_pk_bf16_f32 v20, v40, v41
    v_cvt_pk_bf16_f32 v21, v42, v43

    v_cvt_pk_bf16_f32 v9, v116, v117
    v_cvt_pk_bf16_f32 v10, v118, v119
    v_lshlrev_b32 v40, 16, v9
    v_and_b32 v41, 0xffff0000, v9
    v_lshlrev_b32 v42, 16, v10
    v_and_b32 v43, 0xffff0000, v10
    v_add_f32 v40, v40, v36
    v_add_f32 v41, v41, v37
    v_add_f32 v42, v42, v38
    v_add_f32 v43, v43, v39
    v_cvt_pk_bf16_f32 v22, v40, v41
    v_cvt_pk_bf16_f32 v23, v42, v43

    buffer_store_dwordx2 v[16:17], v1, s[64:67], 0 offen offset:0
    buffer_store_dwordx2 v[18:19], v1, s[64:67], 0 offen offset:32
    buffer_store_dwordx2 v[20:21], v1, s[64:67], 0 offen offset:64
    buffer_store_dwordx2 v[22:23], v1, s[64:67], 0 offen offset:96
    v_add_u32 v1, 32768, v1
    s_nop 1
    v_cvt_pk_bf16_f32 v9, v72, v73
    v_cvt_pk_bf16_f32 v10, v74, v75
    v_lshlrev_b32 v40, 16, v9
    v_and_b32 v41, 0xffff0000, v9
    v_lshlrev_b32 v42, 16, v10
    v_and_b32 v43, 0xffff0000, v10
    v_add_f32 v40, v40, v24
    v_add_f32 v41, v41, v25
    v_add_f32 v42, v42, v26
    v_add_f32 v43, v43, v27
    v_cvt_pk_bf16_f32 v16, v40, v41
    v_cvt_pk_bf16_f32 v17, v42, v43

    v_cvt_pk_bf16_f32 v9, v88, v89
    v_cvt_pk_bf16_f32 v10, v90, v91
    v_lshlrev_b32 v40, 16, v9
    v_and_b32 v41, 0xffff0000, v9
    v_lshlrev_b32 v42, 16, v10
    v_and_b32 v43, 0xffff0000, v10
    v_add_f32 v40, v40, v28
    v_add_f32 v41, v41, v29
    v_add_f32 v42, v42, v30
    v_add_f32 v43, v43, v31
    v_cvt_pk_bf16_f32 v18, v40, v41
    v_cvt_pk_bf16_f32 v19, v42, v43

    v_cvt_pk_bf16_f32 v9, v104, v105
    v_cvt_pk_bf16_f32 v10, v106, v107
    v_lshlrev_b32 v40, 16, v9
    v_and_b32 v41, 0xffff0000, v9
    v_lshlrev_b32 v42, 16, v10
    v_and_b32 v43, 0xffff0000, v10
    v_add_f32 v40, v40, v32
    v_add_f32 v41, v41, v33
    v_add_f32 v42, v42, v34
    v_add_f32 v43, v43, v35
    v_cvt_pk_bf16_f32 v20, v40, v41
    v_cvt_pk_bf16_f32 v21, v42, v43

    v_cvt_pk_bf16_f32 v9, v120, v121
    v_cvt_pk_bf16_f32 v10, v122, v123
    v_lshlrev_b32 v40, 16, v9
    v_and_b32 v41, 0xffff0000, v9
    v_lshlrev_b32 v42, 16, v10
    v_and_b32 v43, 0xffff0000, v10
    v_add_f32 v40, v40, v36
    v_add_f32 v41, v41, v37
    v_add_f32 v42, v42, v38
    v_add_f32 v43, v43, v39
    v_cvt_pk_bf16_f32 v22, v40, v41
    v_cvt_pk_bf16_f32 v23, v42, v43

    buffer_store_dwordx2 v[16:17], v1, s[64:67], 0 offen offset:0
    buffer_store_dwordx2 v[18:19], v1, s[64:67], 0 offen offset:32
    buffer_store_dwordx2 v[20:21], v1, s[64:67], 0 offen offset:64
    buffer_store_dwordx2 v[22:23], v1, s[64:67], 0 offen offset:96
    v_add_u32 v1, 32768, v1
    s_nop 1
    v_cvt_pk_bf16_f32 v9, v76, v77
    v_cvt_pk_bf16_f32 v10, v78, v79
    v_lshlrev_b32 v40, 16, v9
    v_and_b32 v41, 0xffff0000, v9
    v_lshlrev_b32 v42, 16, v10
    v_and_b32 v43, 0xffff0000, v10
    v_add_f32 v40, v40, v24
    v_add_f32 v41, v41, v25
    v_add_f32 v42, v42, v26
    v_add_f32 v43, v43, v27
    v_cvt_pk_bf16_f32 v16, v40, v41
    v_cvt_pk_bf16_f32 v17, v42, v43

    v_cvt_pk_bf16_f32 v9, v92, v93
    v_cvt_pk_bf16_f32 v10, v94, v95
    v_lshlrev_b32 v40, 16, v9
    v_and_b32 v41, 0xffff0000, v9
    v_lshlrev_b32 v42, 16, v10
    v_and_b32 v43, 0xffff0000, v10
    v_add_f32 v40, v40, v28
    v_add_f32 v41, v41, v29
    v_add_f32 v42, v42, v30
    v_add_f32 v43, v43, v31
    v_cvt_pk_bf16_f32 v18, v40, v41
    v_cvt_pk_bf16_f32 v19, v42, v43

    v_cvt_pk_bf16_f32 v9, v108, v109
    v_cvt_pk_bf16_f32 v10, v110, v111
    v_lshlrev_b32 v40, 16, v9
    v_and_b32 v41, 0xffff0000, v9
    v_lshlrev_b32 v42, 16, v10
    v_and_b32 v43, 0xffff0000, v10
    v_add_f32 v40, v40, v32
    v_add_f32 v41, v41, v33
    v_add_f32 v42, v42, v34
    v_add_f32 v43, v43, v35
    v_cvt_pk_bf16_f32 v20, v40, v41
    v_cvt_pk_bf16_f32 v21, v42, v43

    v_cvt_pk_bf16_f32 v9, v124, v125
    v_cvt_pk_bf16_f32 v10, v126, v127
    v_lshlrev_b32 v40, 16, v9
    v_and_b32 v41, 0xffff0000, v9
    v_lshlrev_b32 v42, 16, v10
    v_and_b32 v43, 0xffff0000, v10
    v_add_f32 v40, v40, v36
    v_add_f32 v41, v41, v37
    v_add_f32 v42, v42, v38
    v_add_f32 v43, v43, v39
    v_cvt_pk_bf16_f32 v22, v40, v41
    v_cvt_pk_bf16_f32 v23, v42, v43

    buffer_store_dwordx2 v[16:17], v1, s[64:67], 0 offen offset:0
    buffer_store_dwordx2 v[18:19], v1, s[64:67], 0 offen offset:32
    buffer_store_dwordx2 v[20:21], v1, s[64:67], 0 offen offset:64
    buffer_store_dwordx2 v[22:23], v1, s[64:67], 0 offen offset:96
    v_add_u32 v1, 32768, v1
    s_nop 1
K5_END:
    s_endpgm
.globl k6_comb_kernel
.p2align 8
.type k6_comb_kernel,@function
k6_comb_kernel:
    s_cmp_ge_u32 s2, 1024
    s_cbranch_scc1 K6_END
    s_load_dwordx2 s[8:9], s[0:1], 0
    s_load_dwordx2 s[10:11], s[0:1], 96
    s_load_dwordx2 s[12:13], s[0:1], 112
    s_waitcnt lgkmcnt(0)

    s_mov_b32 s60, s8
    s_and_b32 s61, s9, 0xffff
    s_mov_b32 s62, 4194304
    s_mov_b32 s63, 0x00020000

    s_mov_b32 s64, s10
    s_and_b32 s65, s11, 0xffff
    s_mov_b32 s66, 4194304
    s_mov_b32 s67, 0x00020000

    s_mov_b32 s28, s12
    s_and_b32 s29, s13, 0xffff
    s_mov_b32 s30, 268435456
    s_mov_b32 s31, 0x00020000

    s_lshl_b32 s3, s2, 8
    v_add_u32 v1, s3, v0
    v_lshlrev_b32 v1, 4, v1
    s_mov_b32 s20, 4194304
    s_mov_b32 s21, 20971520
    buffer_load_dwordx4 v[4:7], v1, s[60:63], 0 offen
    buffer_load_dwordx4 v[8:11], v1, s[28:31], s20 offen
    buffer_load_dwordx4 v[12:15], v1, s[28:31], s21 offen
    s_waitcnt vmcnt(0)

    v_lshlrev_b32 v16, 16, v4
    v_and_b32 v17, 0xffff0000, v4
    v_lshlrev_b32 v18, 16, v8
    v_and_b32 v19, 0xffff0000, v8
    v_add_f32 v16, v16, v18
    v_add_f32 v17, v17, v19
    v_cvt_pk_bf16_f32 v20, v16, v17
    v_lshlrev_b32 v16, 16, v20
    v_and_b32 v17, 0xffff0000, v20
    v_lshlrev_b32 v18, 16, v12
    v_and_b32 v19, 0xffff0000, v12
    v_add_f32 v16, v16, v18
    v_add_f32 v17, v17, v19
    v_cvt_pk_bf16_f32 v24, v16, v17

    v_lshlrev_b32 v16, 16, v5
    v_and_b32 v17, 0xffff0000, v5
    v_lshlrev_b32 v18, 16, v9
    v_and_b32 v19, 0xffff0000, v9
    v_add_f32 v16, v16, v18
    v_add_f32 v17, v17, v19
    v_cvt_pk_bf16_f32 v20, v16, v17
    v_lshlrev_b32 v16, 16, v20
    v_and_b32 v17, 0xffff0000, v20
    v_lshlrev_b32 v18, 16, v13
    v_and_b32 v19, 0xffff0000, v13
    v_add_f32 v16, v16, v18
    v_add_f32 v17, v17, v19
    v_cvt_pk_bf16_f32 v25, v16, v17

    v_lshlrev_b32 v16, 16, v6
    v_and_b32 v17, 0xffff0000, v6
    v_lshlrev_b32 v18, 16, v10
    v_and_b32 v19, 0xffff0000, v10
    v_add_f32 v16, v16, v18
    v_add_f32 v17, v17, v19
    v_cvt_pk_bf16_f32 v20, v16, v17
    v_lshlrev_b32 v16, 16, v20
    v_and_b32 v17, 0xffff0000, v20
    v_lshlrev_b32 v18, 16, v14
    v_and_b32 v19, 0xffff0000, v14
    v_add_f32 v16, v16, v18
    v_add_f32 v17, v17, v19
    v_cvt_pk_bf16_f32 v26, v16, v17

    v_lshlrev_b32 v16, 16, v7
    v_and_b32 v17, 0xffff0000, v7
    v_lshlrev_b32 v18, 16, v11
    v_and_b32 v19, 0xffff0000, v11
    v_add_f32 v16, v16, v18
    v_add_f32 v17, v17, v19
    v_cvt_pk_bf16_f32 v20, v16, v17
    v_lshlrev_b32 v16, 16, v20
    v_and_b32 v17, 0xffff0000, v20
    v_lshlrev_b32 v18, 16, v15
    v_and_b32 v19, 0xffff0000, v15
    v_add_f32 v16, v16, v18
    v_add_f32 v17, v17, v19
    v_cvt_pk_bf16_f32 v27, v16, v17

    buffer_store_dwordx4 v[24:27], v1, s[64:67], 0 offen
K6_END:
    s_endpgm
.section .rodata,"a"
.p2align 6
.amdhsa_kernel k1_ln_kernel
  .amdhsa_next_free_vgpr 84
  .amdhsa_next_free_sgpr 102
  .amdhsa_accum_offset 84
  .amdhsa_group_segment_fixed_size 0
  .amdhsa_kernarg_size 120
  .amdhsa_user_sgpr_count 2
  .amdhsa_user_sgpr_kernarg_segment_ptr 1
  .amdhsa_system_sgpr_workgroup_id_x 1
.end_amdhsa_kernel

.amdhsa_kernel k2_gemm_kernel
  .amdhsa_next_free_vgpr 128
  .amdhsa_next_free_sgpr 102
  .amdhsa_accum_offset 128
  .amdhsa_group_segment_fixed_size 0
  .amdhsa_kernarg_size 120
  .amdhsa_user_sgpr_count 2
  .amdhsa_user_sgpr_kernarg_segment_ptr 1
  .amdhsa_system_sgpr_workgroup_id_x 1
.end_amdhsa_kernel

.amdhsa_kernel k3_rec_kernel
  .amdhsa_next_free_vgpr 408
  .amdhsa_next_free_sgpr 102
  .amdhsa_accum_offset 240
  .amdhsa_group_segment_fixed_size 0
  .amdhsa_kernarg_size 120
  .amdhsa_user_sgpr_count 2
  .amdhsa_user_sgpr_kernarg_segment_ptr 1
  .amdhsa_system_sgpr_workgroup_id_x 1
.end_amdhsa_kernel

.amdhsa_kernel k4_attn_kernel
  .amdhsa_next_free_vgpr 216
  .amdhsa_next_free_sgpr 102
  .amdhsa_accum_offset 216
  .amdhsa_group_segment_fixed_size 0
  .amdhsa_kernarg_size 120
  .amdhsa_user_sgpr_count 2
  .amdhsa_user_sgpr_kernarg_segment_ptr 1
  .amdhsa_system_sgpr_workgroup_id_x 1
.end_amdhsa_kernel

.amdhsa_kernel k5_gemm_kernel
  .amdhsa_next_free_vgpr 128
  .amdhsa_next_free_sgpr 102
  .amdhsa_accum_offset 128
  .amdhsa_group_segment_fixed_size 0
  .amdhsa_kernarg_size 120
  .amdhsa_user_sgpr_count 2
  .amdhsa_user_sgpr_kernarg_segment_ptr 1
  .amdhsa_system_sgpr_workgroup_id_x 1
.end_amdhsa_kernel
.amdhsa_kernel k6_comb_kernel
  .amdhsa_next_free_vgpr 32
  .amdhsa_next_free_sgpr 102
  .amdhsa_accum_offset 32
  .amdhsa_group_segment_fixed_size 0
  .amdhsa_kernarg_size 120
  .amdhsa_user_sgpr_count 2
  .amdhsa_user_sgpr_kernarg_segment_ptr 1
  .amdhsa_system_sgpr_workgroup_id_x 1
.end_amdhsa_kernel
```
